```python
import torch

def _softmax(x, axis=-1):
    return torch.softmax(x, dim=axis)
def _gelu(x):
    return torch.nn.functional.gelu(x, approximate="tanh")
def _silu(x):
    return torch.nn.functional.silu(x)
def _sigmoid(x):
    return torch.sigmoid(x)
def _layernorm(x, axis=-1, eps=1e-5):
    m = x.mean(dim=axis, keepdim=True)
    v = x.var(dim=axis, keepdim=True, unbiased=False)
    return (x - m) / torch.sqrt(v + eps)
def _scatter_add(tgt, idx, src, axis=0):
    return tgt.clone().index_add_(axis, idx, src)
def _segment_sum(src, seg, n):
    out = torch.zeros((n,) + src.shape[1:], dtype=src.dtype)
    return out.index_add_(0, seg, src)
def _pad(x, pw):
    flat = tuple(v for pair in reversed(pw) for v in pair)
    return torch.nn.functional.pad(x, flat)

kernel_name = 'standalone__paged_block_table_kv_pagedattention__sampling'

def setup_inputs():

    _w = (lambda a: (lambda t: t.to(torch.bfloat16) if t.is_floating_point() else t)(torch.as_tensor(a)))
    B, Hq, Hkv, Sq, Skv, D = 16, 32, 32, 32, 2048, 128
    bs = 16
    nbps = max(1, Skv // bs)
    num_phys = B * nbps + 4
    bt = torch.randperm(num_phys)[: B * nbps].reshape(B, nbps).to(torch.int64)
    cl = (nbps * bs - (torch.arange(1, B + 1, dtype=torch.int64) * 2654435761) % max(1, nbps * bs // 2)).to(torch.int64)
    return {
        "q": _w((lambda *s: torch.randn(*s, dtype=torch.bfloat16) * 0.8)(B, Hq, Sq, D)),
        "k_cache": _w((lambda *s: torch.randn(*s, dtype=torch.bfloat16) * 0.8)(num_phys, bs, Hkv, D)),
        "v_cache": _w((lambda *s: torch.randn(*s, dtype=torch.bfloat16) * 0.05)(num_phys, bs, Hkv, D)),
        "block_table": _w(bt),
        "context_lens": _w(cl),
    }

def reference(q, k_cache, v_cache, block_table, context_lens):
    B, Hq, Sq, D = q.shape
    bs = k_cache.shape[1]
    Hkv = k_cache.shape[2]
    nbps = block_table.shape[1]
    Skv = nbps * bs
    bt = block_table.reshape(-1)
    k = (lambda x, *d: x.permute(*d))(k_cache[bt].reshape(B, Skv, Hkv, D), 0, 2, 1, 3)
    v = (lambda x, *d: x.permute(*d))(v_cache[bt].reshape(B, Skv, Hkv, D), 0, 2, 1, 3)
    g = Hq // Hkv
    qg = q.reshape(B, Hkv, g, Sq, D)
    scores = torch.einsum("bhgqd,bhkd->bhgqk", qg, k) * (D ** -0.5)
    pos = torch.arange(Skv)
    msk = pos[None, :] < context_lens[:, None]
    scores = torch.where(msk[:, None, None, None, :], scores, -1e9)
    p = _softmax(scores, axis=-1)
    out = torch.einsum("bhgqk,bhkd->bhgqd", p, v)
    return out.reshape(B, Hq, Sq, D)
```

```asm
; @launch grid=(256,1,1) block=(320,1,1) lds=157248
.amdgcn_target "amdgcn-amd-amdhsa--gfx950"
.text
.globl standalone__paged_block_table_kv_pagedattention__sampling_kernel
.p2align 8
.type standalone__paged_block_table_kv_pagedattention__sampling_kernel,@function
standalone__paged_block_table_kv_pagedattention__sampling_kernel:
    s_load_dwordx16 s[4:19], s[0:1], 0
    s_cmp_ge_u32 s2, 256
    s_cbranch_scc1 L_done
    v_lshrrev_b32 v28, 6, v0
    v_and_b32 v1, 63, v0
    v_readfirstlane_b32 s40, v28
    s_and_b32 s41, s2, 7
    s_lshl_b32 s41, s41, 2
    s_lshr_b32 s41, 0x63127504, s41
    s_and_b32 s41, s41, 7
    s_lshr_b32 s42, s2, 3
    v_and_b32 v56, 60, v1
    v_and_b32 v57, 3, v1
    v_lshlrev_b32 v58, 4, v57
    s_cmp_lg_u32 s40, 0
    s_cbranch_scc1 L_consumer
    v_lshrrev_b32 v28, 4, v1
    v_and_b32 v29, 15, v1
    v_lshlrev_b32 v30, 2, v28
    v_xor_b32 v29, v29, v30
    v_lshlrev_b32 v29, 4, v29
    v_lshl_add_u32 v12, v28, 8, v29
    v_xor_b32 v13, 16, v12
    v_xor_b32 v14, 32, v12
    v_xor_b32 v15, 48, v12
    s_mov_b32 s22, 0x400000
    s_mov_b32 s23, 0x20000
    s_lshl_b32 s58, s41, 2
    s_lshr_b32 s32, 0xc07e294b, s58
    s_lshr_b32 s33, 0x5a3f81d6, s58
    s_and_b32 s32, s32, 15
    s_and_b32 s33, s33, 15
    s_lshl_b32 s62, s42, 13
    s_lshl_b32 s86, s32, 18
    s_lshl_b32 s87, s33, 18
    s_add_u32 s86, s86, s62
    s_add_u32 s87, s87, s62
    s_lshl_b32 s52, s32, 9
    s_waitcnt lgkmcnt(0)
    global_load_dword v32, v56, s[12:13]
    global_load_dwordx4 v[36:39], v58, s[12:13]
    s_mov_b32 s20, s4
    s_mov_b32 s21, s5
    s_load_dwordx8 s[24:31], s[10:11], s52
    s_mov_b32 m0, 131072
    s_add_u32 s62, s86, 0
    buffer_load_dwordx4 v12, s[20:23], s62 offen nt lds
    buffer_load_dwordx4 v13, s[20:23], s62 offen offset:1024 nt lds
    buffer_load_dwordx4 v14, s[20:23], s62 offen offset:2048 nt lds
    buffer_load_dwordx4 v15, s[20:23], s62 offen offset:3072 nt lds
    s_mov_b32 m0, 135168
    s_add_u32 s62, s86, 4096
    buffer_load_dwordx4 v12, s[20:23], s62 offen nt lds
    buffer_load_dwordx4 v13, s[20:23], s62 offen offset:1024 nt lds
    buffer_load_dwordx4 v14, s[20:23], s62 offen offset:2048 nt lds
    buffer_load_dwordx4 v15, s[20:23], s62 offen offset:3072 nt lds
    s_mov_b32 m0, 139264
    s_add_u32 s62, s87, 0
    buffer_load_dwordx4 v12, s[20:23], s62 offen nt lds
    buffer_load_dwordx4 v13, s[20:23], s62 offen offset:1024 nt lds
    buffer_load_dwordx4 v14, s[20:23], s62 offen offset:2048 nt lds
    buffer_load_dwordx4 v15, s[20:23], s62 offen offset:3072 nt lds
    s_mov_b32 m0, 143360
    s_add_u32 s62, s87, 4096
    buffer_load_dwordx4 v12, s[20:23], s62 offen nt lds
    buffer_load_dwordx4 v13, s[20:23], s62 offen offset:1024 nt lds
    buffer_load_dwordx4 v14, s[20:23], s62 offen offset:2048 nt lds
    buffer_load_dwordx4 v15, s[20:23], s62 offen offset:3072 nt lds
    s_setprio 3
    v_lshl_add_u32 v6, v28, 15, v29
    v_add_u32 v7, 7168, v6
    v_add_u32 v8, 14336, v6
    v_add_u32 v9, 21504, v6
    v_mov_b32 v2, v6
    v_xor_b32 v3, 16, v7
    v_xor_b32 v4, 32, v8
    v_xor_b32 v5, 48, v9
    s_lshl_b32 s58, s42, 8
    s_add_u32 s36, s6, s58
    s_addc_u32 s37, s7, 0
    s_add_u32 s38, s8, s58
    s_addc_u32 s39, s9, 0
    s_mov_b32 s69, 0
    s_mov_b32 s56, 0
    s_mov_b32 s55, 0
    s_mov_b32 s100, 0
    s_and_b32 s58, s2, 7
    s_lshl_b32 s58, s58, 5
    v_and_b32 v17, 31, v1
    v_add_u32 v17, s58, v17
    s_add_u32 s58, s58, s42
    v_mov_b32 v16, s58
    s_mov_b32 s35, 16
    v_lshrrev_b32 v62, 2, v1
    v_lshlrev_b32 v63, 2, v57
    s_sub_u32 s63, 15, s41
    s_movk_i32 s58, 2047
    s_waitcnt vmcnt(16)
    v_add_u32 v33, -1, v32
    v_add_u32 v36, -1, v36
    v_add_u32 v37, -1, v37
    v_add_u32 v38, -1, v38
    v_add_u32 v39, -1, v39
    v_min_u32 v33, s58, v33
    v_min_u32 v36, s58, v36
    v_min_u32 v37, s58, v37
    v_min_u32 v38, s58, v38
    v_min_u32 v39, s58, v39
    v_lshl_or_b32 v33, v33, 4, v62
    v_sub_u32 v34, v33, v63
    v_lshl_or_b32 v36, v36, 4, 0
    v_lshl_or_b32 v37, v37, 4, 1
    v_lshl_or_b32 v38, v38, 4, 2
    v_lshl_or_b32 v39, v39, 4, 3
    v_sub_u32 v36, v34, v36
    v_sub_u32 v37, v34, v37
    v_sub_u32 v38, v34, v38
    v_sub_u32 v39, v34, v39
    v_lshrrev_b32 v36, 31, v36
    v_lshrrev_b32 v37, 31, v37
    v_lshrrev_b32 v38, 31, v38
    v_lshrrev_b32 v39, 31, v39
    v_add_u32 v36, v36, v37
    v_add3_u32 v36, v36, v38, v39
    s_nop 1
    v_add_u32_dpp v37, v36, v36 quad_perm:[1,0,3,2] row_mask:0xf bank_mask:0xf
    s_nop 1
    v_add_u32_dpp v36, v37, v37 quad_perm:[2,3,0,1] row_mask:0xf bank_mask:0xf
    v_cmp_eq_u32 s[64:65], s41, v36
    v_cmp_eq_u32 s[66:67], s63, v36
    s_ff1_i32_b64 s59, s[64:65]
    s_ff1_i32_b64 s60, s[66:67]
    v_readlane_b32 s45, v33, s59
    v_readlane_b32 s46, v33, s60
    s_lshr_b32 s43, s59, 2
    s_lshr_b32 s44, s60, 2
    s_cmp_lg_u32 s43, s32
    s_cbranch_scc1 L_ld_redo
    s_cmp_lg_u32 s44, s33
    s_cbranch_scc1 L_ld_redo
L_ld_item:
    s_lshr_b32 s48, s45, 11
    s_lshr_b32 s47, s45, 9
    s_lshr_b32 s51, s45, 4
    s_add_u32 s48, s48, 1
    s_add_u32 s47, s47, 1
    s_add_u32 s51, s51, 1
    s_lshl_b32 s50, s48, 1
    s_cmp_ge_u32 s47, s50
    s_addc_u32 s49, 1, 0
    s_add_u32 s50, s50, s48
    s_cmp_ge_u32 s47, s50
    s_addc_u32 s49, s49, 0
    s_add_u32 s50, s50, s48
    s_cmp_ge_u32 s47, s50
    s_addc_u32 s49, s49, 0
    s_mul_i32 s50, s49, s48
    s_sub_u32 s50, s47, s50
    s_mov_b32 s53, s51
    s_mov_b32 s54, s48
    s_branch L_ld_go
L_ld_redo:
    s_waitcnt vmcnt(0) lgkmcnt(0)
    s_lshl_b32 s52, s43, 9
    s_load_dwordx8 s[24:31], s[10:11], s52
    s_lshl_b32 s62, s42, 13
    s_lshl_b32 s86, s43, 18
    s_lshl_b32 s87, s44, 18
    s_add_u32 s86, s86, s62
    s_add_u32 s87, s87, s62
    s_mov_b32 m0, 131072
    s_add_u32 s62, s86, 0
    buffer_load_dwordx4 v12, s[20:23], s62 offen nt lds
    buffer_load_dwordx4 v13, s[20:23], s62 offen offset:1024 nt lds
    buffer_load_dwordx4 v14, s[20:23], s62 offen offset:2048 nt lds
    buffer_load_dwordx4 v15, s[20:23], s62 offen offset:3072 nt lds
    s_mov_b32 m0, 135168
    s_add_u32 s62, s86, 4096
    buffer_load_dwordx4 v12, s[20:23], s62 offen nt lds
    buffer_load_dwordx4 v13, s[20:23], s62 offen offset:1024 nt lds
    buffer_load_dwordx4 v14, s[20:23], s62 offen offset:2048 nt lds
    buffer_load_dwordx4 v15, s[20:23], s62 offen offset:3072 nt lds
    s_mov_b32 m0, 139264
    s_add_u32 s62, s87, 0
    buffer_load_dwordx4 v12, s[20:23], s62 offen nt lds
    buffer_load_dwordx4 v13, s[20:23], s62 offen offset:1024 nt lds
    buffer_load_dwordx4 v14, s[20:23], s62 offen offset:2048 nt lds
    buffer_load_dwordx4 v15, s[20:23], s62 offen offset:3072 nt lds
    s_mov_b32 m0, 143360
    s_add_u32 s62, s87, 4096
    buffer_load_dwordx4 v12, s[20:23], s62 offen nt lds
    buffer_load_dwordx4 v13, s[20:23], s62 offen offset:1024 nt lds
    buffer_load_dwordx4 v14, s[20:23], s62 offen offset:2048 nt lds
    buffer_load_dwordx4 v15, s[20:23], s62 offen offset:3072 nt lds
    s_branch L_ld_item
L_ld_switch:
    s_mov_b32 s100, 1
    s_mov_b32 s56, 0
    s_mov_b32 s45, s46
    s_branch L_ld_item
    .p2align 6
L_ld_next:
    s_xor_b32 s55, s55, 16384
    s_add_u32 s69, s69, 1
    s_add_u32 s56, s56, 1
    v_cmp_le_u32 vcc, s69, v19
    s_bcnt1_i32_b32 s35, vcc_lo
    s_sub_u32 s54, s54, 1
    s_cmp_eq_u32 s54, 0
    s_cbranch_scc1 L_ld_switch
L_ld_go:
    s_add_u32 s59, s69, 1
    v_mov_b32 v18, s59
    s_cmp_lt_u32 s56, s50
    s_addc_u32 s57, s49, 0
    s_lshl3_add_u32 s52, s57, s52
    s_lshl_b32 s59, s44, 9
    s_cmp_eq_u32 s54, 1
    s_cselect_b32 s52, s59, s52
    s_cmp_eq_u32 s100, 0
    s_cselect_b32 s59, 64, s54
    s_lshl_b32 s57, s57, 1
    s_waitcnt lgkmcnt(0)
    s_cmp_eq_u32 s59, 1
    s_cbranch_scc1 L_ld_last
    s_cmp_lg_u32 s57, 8
    s_cbranch_scc1 L_ld_small
    s_cmp_gt_i32 s35, 23
    s_cbranch_scc1 L_fa2
    s_cmp_le_i32 s35, 9
    s_cbranch_scc1 L_fa0
L_fa1:
    global_store_byte v16, v18, s[16:17]
    global_load_ubyte v19, v17, s[16:17] sc1
    s_min_u32 s59, s24, 0x803
    s_min_i32 s60, s53, 16
    s_lshl_b32 s88, s59, 17
    s_max_i32 s60, s60, 0
    s_sub_i32 s53, s53, 16
    s_lshl_b32 s64, s60, 13
    s_add_u32 m0, s55, 0
    s_add_u32 s20, s36, s88
    s_addc_u32 s21, s37, 0
    s_mov_b32 s22, s64
    s_waitcnt vmcnt(20)
    buffer_load_dwordx4 v2, s[20:23], 0 offen nt lds
    s_waitcnt vmcnt(20)
    buffer_load_dwordx4 v3, s[20:23], 0 offen offset:1024 nt lds
    s_waitcnt vmcnt(20)
    buffer_load_dwordx4 v4, s[20:23], 0 offen offset:2048 nt lds
    s_waitcnt vmcnt(20)
    buffer_load_dwordx4 v5, s[20:23], 0 offen offset:3072 nt lds
    s_min_u32 s59, s25, 0x803
    s_min_i32 s60, s53, 16
    s_lshl_b32 s89, s59, 17
    s_max_i32 s60, s60, 0
    s_sub_i32 s53, s53, 16
    s_lshl_b32 s65, s60, 13
    s_add_u32 m0, s55, 4096
    s_add_u32 s20, s36, s89
    s_addc_u32 s21, s37, 0
    s_mov_b32 s22, s65
    s_waitcnt vmcnt(20)
    buffer_load_dwordx4 v2, s[20:23], 0 offen nt lds
    s_waitcnt vmcnt(20)
    buffer_load_dwordx4 v3, s[20:23], 0 offen offset:1024 nt lds
    s_waitcnt vmcnt(20)
    buffer_load_dwordx4 v4, s[20:23], 0 offen offset:2048 nt lds
    s_waitcnt vmcnt(20)
    buffer_load_dwordx4 v5, s[20:23], 0 offen offset:3072 nt lds
    s_min_u32 s59, s26, 0x803
    s_min_i32 s60, s53, 16
    s_lshl_b32 s90, s59, 17
    s_max_i32 s60, s60, 0
    s_sub_i32 s53, s53, 16
    s_lshl_b32 s66, s60, 13
    s_add_u32 m0, s55, 32768
    s_add_u32 s20, s36, s90
    s_addc_u32 s21, s37, 0
    s_mov_b32 s22, s66
    s_waitcnt vmcnt(20)
    buffer_load_dwordx4 v2, s[20:23], 0 offen nt lds
    s_waitcnt vmcnt(20)
    buffer_load_dwordx4 v3, s[20:23], 0 offen offset:1024 nt lds
    s_waitcnt vmcnt(20)
    buffer_load_dwordx4 v4, s[20:23], 0 offen offset:2048 nt lds
    s_waitcnt vmcnt(20)
    buffer_load_dwordx4 v5, s[20:23], 0 offen offset:3072 nt lds
    s_min_u32 s59, s27, 0x803
    s_min_i32 s60, s53, 16
    s_lshl_b32 s91, s59, 17
    s_max_i32 s60, s60, 0
    s_sub_i32 s53, s53, 16
    s_lshl_b32 s67, s60, 13
    s_add_u32 m0, s55, 36864
    s_add_u32 s20, s36, s91
    s_addc_u32 s21, s37, 0
    s_mov_b32 s22, s67
    s_waitcnt vmcnt(20)
    buffer_load_dwordx4 v2, s[20:23], 0 offen nt lds
    s_waitcnt vmcnt(20)
    buffer_load_dwordx4 v3, s[20:23], 0 offen offset:1024 nt lds
    s_waitcnt vmcnt(20)
    buffer_load_dwordx4 v4, s[20:23], 0 offen offset:2048 nt lds
    s_waitcnt vmcnt(20)
    buffer_load_dwordx4 v5, s[20:23], 0 offen offset:3072 nt lds
    s_min_u32 s59, s28, 0x803
    s_min_i32 s60, s53, 16
    s_lshl_b32 s92, s59, 17
    s_max_i32 s60, s60, 0
    s_sub_i32 s53, s53, 16
    s_lshl_b32 s96, s60, 13
    s_add_u32 m0, s55, 65536
    s_add_u32 s20, s36, s92
    s_addc_u32 s21, s37, 0
    s_mov_b32 s22, s96
    s_waitcnt vmcnt(20)
    buffer_load_dwordx4 v2, s[20:23], 0 offen nt lds
    s_waitcnt vmcnt(20)
    buffer_load_dwordx4 v3, s[20:23], 0 offen offset:1024 nt lds
    s_waitcnt vmcnt(20)
    buffer_load_dwordx4 v4, s[20:23], 0 offen offset:2048 nt lds
    s_waitcnt vmcnt(20)
    s_cmp_eq_u32 s69, 0
    s_cbranch_scc1 L_nb1
    s_barrier
L_nb1:
    buffer_load_dwordx4 v5, s[20:23], 0 offen offset:3072 nt lds
    s_min_u32 s59, s29, 0x803
    s_min_i32 s60, s53, 16
    s_lshl_b32 s93, s59, 17
    s_max_i32 s60, s60, 0
    s_sub_i32 s53, s53, 16
    s_lshl_b32 s97, s60, 13
    s_add_u32 m0, s55, 69632
    s_add_u32 s20, s36, s93
    s_addc_u32 s21, s37, 0
    s_mov_b32 s22, s97
    s_waitcnt vmcnt(20)
    buffer_load_dwordx4 v2, s[20:23], 0 offen nt lds
    s_waitcnt vmcnt(20)
    buffer_load_dwordx4 v3, s[20:23], 0 offen offset:1024 nt lds
    s_waitcnt vmcnt(20)
    buffer_load_dwordx4 v4, s[20:23], 0 offen offset:2048 nt lds
    s_waitcnt vmcnt(20)
    buffer_load_dwordx4 v5, s[20:23], 0 offen offset:3072 nt lds
    s_min_u32 s59, s30, 0x803
    s_min_i32 s60, s53, 16
    s_lshl_b32 s94, s59, 17
    s_max_i32 s60, s60, 0
    s_sub_i32 s53, s53, 16
    s_lshl_b32 s98, s60, 13
    s_add_u32 m0, s55, 98304
    s_add_u32 s20, s36, s94
    s_addc_u32 s21, s37, 0
    s_mov_b32 s22, s98
    s_waitcnt vmcnt(20)
    buffer_load_dwordx4 v2, s[20:23], 0 offen nt lds
    s_waitcnt vmcnt(20)
    buffer_load_dwordx4 v3, s[20:23], 0 offen offset:1024 nt lds
    s_waitcnt vmcnt(20)
    buffer_load_dwordx4 v4, s[20:23], 0 offen offset:2048 nt lds
    s_waitcnt vmcnt(20)
    buffer_load_dwordx4 v5, s[20:23], 0 offen offset:3072 nt lds
    s_min_u32 s59, s31, 0x803
    s_min_i32 s60, s53, 16
    s_lshl_b32 s95, s59, 17
    s_max_i32 s60, s60, 0
    s_sub_i32 s53, s53, 16
    s_lshl_b32 s99, s60, 13
    s_add_u32 m0, s55, 102400
    s_add_u32 s20, s36, s95
    s_addc_u32 s21, s37, 0
    s_mov_b32 s22, s99
    s_waitcnt vmcnt(20)
    buffer_load_dwordx4 v2, s[20:23], 0 offen nt lds
    s_waitcnt vmcnt(20)
    buffer_load_dwordx4 v3, s[20:23], 0 offen offset:1024 nt lds
    s_waitcnt vmcnt(20)
    buffer_load_dwordx4 v4, s[20:23], 0 offen offset:2048 nt lds
    s_waitcnt vmcnt(20)
    buffer_load_dwordx4 v5, s[20:23], 0 offen offset:3072 nt lds
    s_add_u32 s59, s52, 0
    s_min_u32 s59, s59, 8184
    s_load_dwordx2 s[24:25], s[10:11], s59
    s_add_u32 m0, s55, 8192
    s_add_u32 s20, s38, s88
    s_addc_u32 s21, s39, 0
    s_mov_b32 s22, s64
    s_waitcnt vmcnt(20)
    buffer_load_dwordx4 v6, s[20:23], 0 offen nt lds
    s_waitcnt vmcnt(20)
    buffer_load_dwordx4 v7, s[20:23], 0 offen offset:1024 nt lds
    s_waitcnt vmcnt(20)
    buffer_load_dwordx4 v8, s[20:23], 0 offen offset:2048 nt lds
    s_waitcnt vmcnt(20)
    buffer_load_dwordx4 v9, s[20:23], 0 offen offset:3072 nt lds
    s_add_u32 s59, s52, 8
    s_min_u32 s59, s59, 8184
    s_load_dwordx2 s[26:27], s[10:11], s59
    s_add_u32 m0, s55, 12288
    s_add_u32 s20, s38, s89
    s_addc_u32 s21, s39, 0
    s_mov_b32 s22, s65
    s_waitcnt vmcnt(20)
    buffer_load_dwordx4 v6, s[20:23], 0 offen nt lds
    s_waitcnt vmcnt(20)
    buffer_load_dwordx4 v7, s[20:23], 0 offen offset:1024 nt lds
    s_waitcnt vmcnt(20)
    buffer_load_dwordx4 v8, s[20:23], 0 offen offset:2048 nt lds
    s_waitcnt vmcnt(20)
    buffer_load_dwordx4 v9, s[20:23], 0 offen offset:3072 nt lds
    s_add_u32 s59, s52, 16
    s_min_u32 s59, s59, 8184
    s_load_dwordx2 s[28:29], s[10:11], s59
    s_add_u32 m0, s55, 40960
    s_add_u32 s20, s38, s90
    s_addc_u32 s21, s39, 0
    s_mov_b32 s22, s66
    s_waitcnt vmcnt(20)
    buffer_load_dwordx4 v6, s[20:23], 0 offen nt lds
    s_waitcnt vmcnt(20)
    buffer_load_dwordx4 v7, s[20:23], 0 offen offset:1024 nt lds
    s_waitcnt vmcnt(20)
    buffer_load_dwordx4 v8, s[20:23], 0 offen offset:2048 nt lds
    s_waitcnt vmcnt(20)
    buffer_load_dwordx4 v9, s[20:23], 0 offen offset:3072 nt lds
    s_add_u32 s59, s52, 24
    s_min_u32 s59, s59, 8184
    s_load_dwordx2 s[30:31], s[10:11], s59
    s_add_u32 m0, s55, 45056
    s_add_u32 s20, s38, s91
    s_addc_u32 s21, s39, 0
    s_mov_b32 s22, s67
    s_waitcnt vmcnt(20)
    buffer_load_dwordx4 v6, s[20:23], 0 offen nt lds
    s_waitcnt vmcnt(20)
    buffer_load_dwordx4 v7, s[20:23], 0 offen offset:1024 nt lds
    s_waitcnt vmcnt(20)
    buffer_load_dwordx4 v8, s[20:23], 0 offen offset:2048 nt lds
    s_waitcnt vmcnt(20)
    buffer_load_dwordx4 v9, s[20:23], 0 offen offset:3072 nt lds
    s_add_u32 m0, s55, 73728
    s_add_u32 s20, s38, s92
    s_addc_u32 s21, s39, 0
    s_mov_b32 s22, s96
    s_waitcnt vmcnt(20)
    buffer_load_dwordx4 v6, s[20:23], 0 offen nt lds
    s_waitcnt vmcnt(20)
    buffer_load_dwordx4 v7, s[20:23], 0 offen offset:1024 nt lds
    s_waitcnt vmcnt(20)
    buffer_load_dwordx4 v8, s[20:23], 0 offen offset:2048 nt lds
    s_waitcnt vmcnt(20)
    buffer_load_dwordx4 v9, s[20:23], 0 offen offset:3072 nt lds
    s_add_u32 m0, s55, 77824
    s_add_u32 s20, s38, s93
    s_addc_u32 s21, s39, 0
    s_mov_b32 s22, s97
    s_waitcnt vmcnt(20)
    s_barrier
    buffer_load_dwordx4 v6, s[20:23], 0 offen nt lds
    s_waitcnt vmcnt(20)
    buffer_load_dwordx4 v7, s[20:23], 0 offen offset:1024 nt lds
    s_waitcnt vmcnt(20)
    buffer_load_dwordx4 v8, s[20:23], 0 offen offset:2048 nt lds
    s_waitcnt vmcnt(20)
    buffer_load_dwordx4 v9, s[20:23], 0 offen offset:3072 nt lds
    s_add_u32 m0, s55, 106496
    s_add_u32 s20, s38, s94
    s_addc_u32 s21, s39, 0
    s_mov_b32 s22, s98
    s_waitcnt vmcnt(20)
    buffer_load_dwordx4 v6, s[20:23], 0 offen nt lds
    s_waitcnt vmcnt(20)
    buffer_load_dwordx4 v7, s[20:23], 0 offen offset:1024 nt lds
    s_waitcnt vmcnt(20)
    buffer_load_dwordx4 v8, s[20:23], 0 offen offset:2048 nt lds
    s_waitcnt vmcnt(20)
    buffer_load_dwordx4 v9, s[20:23], 0 offen offset:3072 nt lds
    s_add_u32 m0, s55, 110592
    s_add_u32 s20, s38, s95
    s_addc_u32 s21, s39, 0
    s_mov_b32 s22, s99
    s_waitcnt vmcnt(20)
    buffer_load_dwordx4 v6, s[20:23], 0 offen nt lds
    s_waitcnt vmcnt(20)
    buffer_load_dwordx4 v7, s[20:23], 0 offen offset:1024 nt lds
    s_waitcnt vmcnt(20)
    buffer_load_dwordx4 v8, s[20:23], 0 offen offset:2048 nt lds
    s_waitcnt vmcnt(20)
    buffer_load_dwordx4 v9, s[20:23], 0 offen offset:3072 nt lds
    s_branch L_ld_next
L_fa0:
    global_store_byte v16, v18, s[16:17]
    global_load_ubyte v19, v17, s[16:17] sc1
    s_min_u32 s59, s24, 0x803
    s_min_i32 s60, s53, 16
    s_lshl_b32 s88, s59, 17
    s_max_i32 s60, s60, 0
    s_sub_i32 s53, s53, 16
    s_lshl_b32 s64, s60, 13
    s_add_u32 m0, s55, 0
    s_add_u32 s20, s36, s88
    s_addc_u32 s21, s37, 0
    s_mov_b32 s22, s64
    s_waitcnt vmcnt(18)
    buffer_load_dwordx4 v2, s[20:23], 0 offen nt lds
    s_waitcnt vmcnt(19)
    buffer_load_dwordx4 v3, s[20:23], 0 offen offset:1024 nt lds
    s_waitcnt vmcnt(18)
    buffer_load_dwordx4 v4, s[20:23], 0 offen offset:2048 nt lds
    s_waitcnt vmcnt(19)
    buffer_load_dwordx4 v5, s[20:23], 0 offen offset:3072 nt lds
    s_min_u32 s59, s25, 0x803
    s_min_i32 s60, s53, 16
    s_lshl_b32 s89, s59, 17
    s_max_i32 s60, s60, 0
    s_sub_i32 s53, s53, 16
    s_lshl_b32 s65, s60, 13
    s_add_u32 m0, s55, 4096
    s_add_u32 s20, s36, s89
    s_addc_u32 s21, s37, 0
    s_mov_b32 s22, s65
    s_waitcnt vmcnt(18)
    buffer_load_dwordx4 v2, s[20:23], 0 offen nt lds
    s_waitcnt vmcnt(19)
    buffer_load_dwordx4 v3, s[20:23], 0 offen offset:1024 nt lds
    s_waitcnt vmcnt(18)
    buffer_load_dwordx4 v4, s[20:23], 0 offen offset:2048 nt lds
    s_waitcnt vmcnt(19)
    buffer_load_dwordx4 v5, s[20:23], 0 offen offset:3072 nt lds
    s_min_u32 s59, s26, 0x803
    s_min_i32 s60, s53, 16
    s_lshl_b32 s90, s59, 17
    s_max_i32 s60, s60, 0
    s_sub_i32 s53, s53, 16
    s_lshl_b32 s66, s60, 13
    s_add_u32 m0, s55, 32768
    s_add_u32 s20, s36, s90
    s_addc_u32 s21, s37, 0
    s_mov_b32 s22, s66
    s_waitcnt vmcnt(18)
    buffer_load_dwordx4 v2, s[20:23], 0 offen nt lds
    s_waitcnt vmcnt(19)
    buffer_load_dwordx4 v3, s[20:23], 0 offen offset:1024 nt lds
    s_waitcnt vmcnt(18)
    buffer_load_dwordx4 v4, s[20:23], 0 offen offset:2048 nt lds
    s_waitcnt vmcnt(19)
    buffer_load_dwordx4 v5, s[20:23], 0 offen offset:3072 nt lds
    s_min_u32 s59, s27, 0x803
    s_min_i32 s60, s53, 16
    s_lshl_b32 s91, s59, 17
    s_max_i32 s60, s60, 0
    s_sub_i32 s53, s53, 16
    s_lshl_b32 s67, s60, 13
    s_add_u32 m0, s55, 36864
    s_add_u32 s20, s36, s91
    s_addc_u32 s21, s37, 0
    s_mov_b32 s22, s67
    s_waitcnt vmcnt(18)
    buffer_load_dwordx4 v2, s[20:23], 0 offen nt lds
    s_waitcnt vmcnt(19)
    buffer_load_dwordx4 v3, s[20:23], 0 offen offset:1024 nt lds
    s_waitcnt vmcnt(18)
    buffer_load_dwordx4 v4, s[20:23], 0 offen offset:2048 nt lds
    s_waitcnt vmcnt(19)
    buffer_load_dwordx4 v5, s[20:23], 0 offen offset:3072 nt lds
    s_min_u32 s59, s28, 0x803
    s_min_i32 s60, s53, 16
    s_lshl_b32 s92, s59, 17
    s_max_i32 s60, s60, 0
    s_sub_i32 s53, s53, 16
    s_lshl_b32 s96, s60, 13
    s_add_u32 m0, s55, 65536
    s_add_u32 s20, s36, s92
    s_addc_u32 s21, s37, 0
    s_mov_b32 s22, s96
    s_waitcnt vmcnt(18)
    buffer_load_dwordx4 v2, s[20:23], 0 offen nt lds
    s_waitcnt vmcnt(19)
    buffer_load_dwordx4 v3, s[20:23], 0 offen offset:1024 nt lds
    s_waitcnt vmcnt(18)
    s_cmp_eq_u32 s69, 0
    s_cbranch_scc1 L_nb2
    s_barrier
L_nb2:
    buffer_load_dwordx4 v4, s[20:23], 0 offen offset:2048 nt lds
    s_waitcnt vmcnt(19)
    buffer_load_dwordx4 v5, s[20:23], 0 offen offset:3072 nt lds
    s_min_u32 s59, s29, 0x803
    s_min_i32 s60, s53, 16
    s_lshl_b32 s93, s59, 17
    s_max_i32 s60, s60, 0
    s_sub_i32 s53, s53, 16
    s_lshl_b32 s97, s60, 13
    s_add_u32 m0, s55, 69632
    s_add_u32 s20, s36, s93
    s_addc_u32 s21, s37, 0
    s_mov_b32 s22, s97
    s_waitcnt vmcnt(18)
    buffer_load_dwordx4 v2, s[20:23], 0 offen nt lds
    s_waitcnt vmcnt(19)
    buffer_load_dwordx4 v3, s[20:23], 0 offen offset:1024 nt lds
    s_waitcnt vmcnt(18)
    buffer_load_dwordx4 v4, s[20:23], 0 offen offset:2048 nt lds
    s_waitcnt vmcnt(19)
    buffer_load_dwordx4 v5, s[20:23], 0 offen offset:3072 nt lds
    s_min_u32 s59, s30, 0x803
    s_min_i32 s60, s53, 16
    s_lshl_b32 s94, s59, 17
    s_max_i32 s60, s60, 0
    s_sub_i32 s53, s53, 16
    s_lshl_b32 s98, s60, 13
    s_add_u32 m0, s55, 98304
    s_add_u32 s20, s36, s94
    s_addc_u32 s21, s37, 0
    s_mov_b32 s22, s98
    s_waitcnt vmcnt(18)
    buffer_load_dwordx4 v2, s[20:23], 0 offen nt lds
    s_waitcnt vmcnt(19)
    buffer_load_dwordx4 v3, s[20:23], 0 offen offset:1024 nt lds
    s_waitcnt vmcnt(18)
    buffer_load_dwordx4 v4, s[20:23], 0 offen offset:2048 nt lds
    s_waitcnt vmcnt(19)
    buffer_load_dwordx4 v5, s[20:23], 0 offen offset:3072 nt lds
    s_min_u32 s59, s31, 0x803
    s_min_i32 s60, s53, 16
    s_lshl_b32 s95, s59, 17
    s_max_i32 s60, s60, 0
    s_sub_i32 s53, s53, 16
    s_lshl_b32 s99, s60, 13
    s_add_u32 m0, s55, 102400
    s_add_u32 s20, s36, s95
    s_addc_u32 s21, s37, 0
    s_mov_b32 s22, s99
    s_waitcnt vmcnt(18)
    buffer_load_dwordx4 v2, s[20:23], 0 offen nt lds
    s_waitcnt vmcnt(19)
    buffer_load_dwordx4 v3, s[20:23], 0 offen offset:1024 nt lds
    s_waitcnt vmcnt(18)
    buffer_load_dwordx4 v4, s[20:23], 0 offen offset:2048 nt lds
    s_waitcnt vmcnt(19)
    buffer_load_dwordx4 v5, s[20:23], 0 offen offset:3072 nt lds
    s_add_u32 s59, s52, 0
    s_min_u32 s59, s59, 8184
    s_load_dwordx2 s[24:25], s[10:11], s59
    s_add_u32 m0, s55, 8192
    s_add_u32 s20, s38, s88
    s_addc_u32 s21, s39, 0
    s_mov_b32 s22, s64
    s_waitcnt vmcnt(18)
    buffer_load_dwordx4 v6, s[20:23], 0 offen nt lds
    s_waitcnt vmcnt(19)
    buffer_load_dwordx4 v7, s[20:23], 0 offen offset:1024 nt lds
    s_waitcnt vmcnt(18)
    buffer_load_dwordx4 v8, s[20:23], 0 offen offset:2048 nt lds
    s_waitcnt vmcnt(19)
    buffer_load_dwordx4 v9, s[20:23], 0 offen offset:3072 nt lds
    s_add_u32 s59, s52, 8
    s_min_u32 s59, s59, 8184
    s_load_dwordx2 s[26:27], s[10:11], s59
    s_add_u32 m0, s55, 12288
    s_add_u32 s20, s38, s89
    s_addc_u32 s21, s39, 0
    s_mov_b32 s22, s65
    s_waitcnt vmcnt(18)
    buffer_load_dwordx4 v6, s[20:23], 0 offen nt lds
    s_waitcnt vmcnt(19)
    buffer_load_dwordx4 v7, s[20:23], 0 offen offset:1024 nt lds
    s_waitcnt vmcnt(18)
    buffer_load_dwordx4 v8, s[20:23], 0 offen offset:2048 nt lds
    s_waitcnt vmcnt(19)
    buffer_load_dwordx4 v9, s[20:23], 0 offen offset:3072 nt lds
    s_add_u32 s59, s52, 16
    s_min_u32 s59, s59, 8184
    s_load_dwordx2 s[28:29], s[10:11], s59
    s_add_u32 m0, s55, 40960
    s_add_u32 s20, s38, s90
    s_addc_u32 s21, s39, 0
    s_mov_b32 s22, s66
    s_waitcnt vmcnt(18)
    buffer_load_dwordx4 v6, s[20:23], 0 offen nt lds
    s_waitcnt vmcnt(19)
    buffer_load_dwordx4 v7, s[20:23], 0 offen offset:1024 nt lds
    s_waitcnt vmcnt(18)
    buffer_load_dwordx4 v8, s[20:23], 0 offen offset:2048 nt lds
    s_waitcnt vmcnt(19)
    buffer_load_dwordx4 v9, s[20:23], 0 offen offset:3072 nt lds
    s_add_u32 s59, s52, 24
    s_min_u32 s59, s59, 8184
    s_load_dwordx2 s[30:31], s[10:11], s59
    s_add_u32 m0, s55, 45056
    s_add_u32 s20, s38, s91
    s_addc_u32 s21, s39, 0
    s_mov_b32 s22, s67
    s_waitcnt vmcnt(18)
    buffer_load_dwordx4 v6, s[20:23], 0 offen nt lds
    s_waitcnt vmcnt(19)
    buffer_load_dwordx4 v7, s[20:23], 0 offen offset:1024 nt lds
    s_waitcnt vmcnt(18)
    buffer_load_dwordx4 v8, s[20:23], 0 offen offset:2048 nt lds
    s_waitcnt vmcnt(19)
    buffer_load_dwordx4 v9, s[20:23], 0 offen offset:3072 nt lds
    s_add_u32 m0, s55, 73728
    s_add_u32 s20, s38, s92
    s_addc_u32 s21, s39, 0
    s_mov_b32 s22, s96
    s_waitcnt vmcnt(18)
    buffer_load_dwordx4 v6, s[20:23], 0 offen nt lds
    s_waitcnt vmcnt(19)
    buffer_load_dwordx4 v7, s[20:23], 0 offen offset:1024 nt lds
    s_waitcnt vmcnt(18)
    s_barrier
    buffer_load_dwordx4 v8, s[20:23], 0 offen offset:2048 nt lds
    s_waitcnt vmcnt(19)
    buffer_load_dwordx4 v9, s[20:23], 0 offen offset:3072 nt lds
    s_add_u32 m0, s55, 77824
    s_add_u32 s20, s38, s93
    s_addc_u32 s21, s39, 0
    s_mov_b32 s22, s97
    s_waitcnt vmcnt(18)
    buffer_load_dwordx4 v6, s[20:23], 0 offen nt lds
    s_waitcnt vmcnt(19)
    buffer_load_dwordx4 v7, s[20:23], 0 offen offset:1024 nt lds
    s_waitcnt vmcnt(18)
    buffer_load_dwordx4 v8, s[20:23], 0 offen offset:2048 nt lds
    s_waitcnt vmcnt(19)
    buffer_load_dwordx4 v9, s[20:23], 0 offen offset:3072 nt lds
    s_add_u32 m0, s55, 106496
    s_add_u32 s20, s38, s94
    s_addc_u32 s21, s39, 0
    s_mov_b32 s22, s98
    s_waitcnt vmcnt(18)
    buffer_load_dwordx4 v6, s[20:23], 0 offen nt lds
    s_waitcnt vmcnt(19)
    buffer_load_dwordx4 v7, s[20:23], 0 offen offset:1024 nt lds
    s_waitcnt vmcnt(18)
    buffer_load_dwordx4 v8, s[20:23], 0 offen offset:2048 nt lds
    s_waitcnt vmcnt(19)
    buffer_load_dwordx4 v9, s[20:23], 0 offen offset:3072 nt lds
    s_add_u32 m0, s55, 110592
    s_add_u32 s20, s38, s95
    s_addc_u32 s21, s39, 0
    s_mov_b32 s22, s99
    s_waitcnt vmcnt(18)
    buffer_load_dwordx4 v6, s[20:23], 0 offen nt lds
    s_waitcnt vmcnt(19)
    buffer_load_dwordx4 v7, s[20:23], 0 offen offset:1024 nt lds
    s_waitcnt vmcnt(18)
    buffer_load_dwordx4 v8, s[20:23], 0 offen offset:2048 nt lds
    s_waitcnt vmcnt(19)
    buffer_load_dwordx4 v9, s[20:23], 0 offen offset:3072 nt lds
    s_branch L_ld_next
L_fa2:
    global_store_byte v16, v18, s[16:17]
    global_load_ubyte v19, v17, s[16:17] sc1
    s_min_u32 s59, s24, 0x803
    s_min_i32 s60, s53, 16
    s_lshl_b32 s88, s59, 17
    s_max_i32 s60, s60, 0
    s_sub_i32 s53, s53, 16
    s_lshl_b32 s64, s60, 13
    s_add_u32 m0, s55, 0
    s_add_u32 s20, s36, s88
    s_addc_u32 s21, s37, 0
    s_mov_b32 s22, s64
    s_waitcnt vmcnt(21)
    buffer_load_dwordx4 v2, s[20:23], 0 offen nt lds
    s_waitcnt vmcnt(22)
    buffer_load_dwordx4 v3, s[20:23], 0 offen offset:1024 nt lds
    s_waitcnt vmcnt(21)
    buffer_load_dwordx4 v4, s[20:23], 0 offen offset:2048 nt lds
    s_waitcnt vmcnt(22)
    buffer_load_dwordx4 v5, s[20:23], 0 offen offset:3072 nt lds
    s_min_u32 s59, s25, 0x803
    s_min_i32 s60, s53, 16
    s_lshl_b32 s89, s59, 17
    s_max_i32 s60, s60, 0
    s_sub_i32 s53, s53, 16
    s_lshl_b32 s65, s60, 13
    s_add_u32 m0, s55, 4096
    s_add_u32 s20, s36, s89
    s_addc_u32 s21, s37, 0
    s_mov_b32 s22, s65
    s_waitcnt vmcnt(21)
    buffer_load_dwordx4 v2, s[20:23], 0 offen nt lds
    s_waitcnt vmcnt(22)
    buffer_load_dwordx4 v3, s[20:23], 0 offen offset:1024 nt lds
    s_waitcnt vmcnt(21)
    buffer_load_dwordx4 v4, s[20:23], 0 offen offset:2048 nt lds
    s_waitcnt vmcnt(22)
    buffer_load_dwordx4 v5, s[20:23], 0 offen offset:3072 nt lds
    s_min_u32 s59, s26, 0x803
    s_min_i32 s60, s53, 16
    s_lshl_b32 s90, s59, 17
    s_max_i32 s60, s60, 0
    s_sub_i32 s53, s53, 16
    s_lshl_b32 s66, s60, 13
    s_add_u32 m0, s55, 32768
    s_add_u32 s20, s36, s90
    s_addc_u32 s21, s37, 0
    s_mov_b32 s22, s66
    s_waitcnt vmcnt(21)
    buffer_load_dwordx4 v2, s[20:23], 0 offen nt lds
    s_waitcnt vmcnt(22)
    buffer_load_dwordx4 v3, s[20:23], 0 offen offset:1024 nt lds
    s_waitcnt vmcnt(21)
    buffer_load_dwordx4 v4, s[20:23], 0 offen offset:2048 nt lds
    s_waitcnt vmcnt(22)
    buffer_load_dwordx4 v5, s[20:23], 0 offen offset:3072 nt lds
    s_min_u32 s59, s27, 0x803
    s_min_i32 s60, s53, 16
    s_lshl_b32 s91, s59, 17
    s_max_i32 s60, s60, 0
    s_sub_i32 s53, s53, 16
    s_lshl_b32 s67, s60, 13
    s_add_u32 m0, s55, 36864
    s_add_u32 s20, s36, s91
    s_addc_u32 s21, s37, 0
    s_mov_b32 s22, s67
    s_waitcnt vmcnt(21)
    buffer_load_dwordx4 v2, s[20:23], 0 offen nt lds
    s_waitcnt vmcnt(22)
    buffer_load_dwordx4 v3, s[20:23], 0 offen offset:1024 nt lds
    s_waitcnt vmcnt(21)
    buffer_load_dwordx4 v4, s[20:23], 0 offen offset:2048 nt lds
    s_waitcnt vmcnt(22)
    buffer_load_dwordx4 v5, s[20:23], 0 offen offset:3072 nt lds
    s_min_u32 s59, s28, 0x803
    s_min_i32 s60, s53, 16
    s_lshl_b32 s92, s59, 17
    s_max_i32 s60, s60, 0
    s_sub_i32 s53, s53, 16
    s_lshl_b32 s96, s60, 13
    s_add_u32 m0, s55, 65536
    s_add_u32 s20, s36, s92
    s_addc_u32 s21, s37, 0
    s_mov_b32 s22, s96
    s_waitcnt vmcnt(21)
    buffer_load_dwordx4 v2, s[20:23], 0 offen nt lds
    s_waitcnt vmcnt(22)
    buffer_load_dwordx4 v3, s[20:23], 0 offen offset:1024 nt lds
    s_waitcnt vmcnt(21)
    buffer_load_dwordx4 v4, s[20:23], 0 offen offset:2048 nt lds
    s_waitcnt vmcnt(22)
    buffer_load_dwordx4 v5, s[20:23], 0 offen offset:3072 nt lds
    s_min_u32 s59, s29, 0x803
    s_min_i32 s60, s53, 16
    s_lshl_b32 s93, s59, 17
    s_max_i32 s60, s60, 0
    s_sub_i32 s53, s53, 16
    s_lshl_b32 s97, s60, 13
    s_add_u32 m0, s55, 69632
    s_add_u32 s20, s36, s93
    s_addc_u32 s21, s37, 0
    s_mov_b32 s22, s97
    s_waitcnt vmcnt(21)
    s_cmp_eq_u32 s69, 0
    s_cbranch_scc1 L_nb3
    s_barrier
L_nb3:
    buffer_load_dwordx4 v2, s[20:23], 0 offen nt lds
    s_waitcnt vmcnt(22)
    buffer_load_dwordx4 v3, s[20:23], 0 offen offset:1024 nt lds
    s_waitcnt vmcnt(21)
    buffer_load_dwordx4 v4, s[20:23], 0 offen offset:2048 nt lds
    s_waitcnt vmcnt(22)
    buffer_load_dwordx4 v5, s[20:23], 0 offen offset:3072 nt lds
    s_min_u32 s59, s30, 0x803
    s_min_i32 s60, s53, 16
    s_lshl_b32 s94, s59, 17
    s_max_i32 s60, s60, 0
    s_sub_i32 s53, s53, 16
    s_lshl_b32 s98, s60, 13
    s_add_u32 m0, s55, 98304
    s_add_u32 s20, s36, s94
    s_addc_u32 s21, s37, 0
    s_mov_b32 s22, s98
    s_waitcnt vmcnt(21)
    buffer_load_dwordx4 v2, s[20:23], 0 offen nt lds
    s_waitcnt vmcnt(22)
    buffer_load_dwordx4 v3, s[20:23], 0 offen offset:1024 nt lds
    s_waitcnt vmcnt(21)
    buffer_load_dwordx4 v4, s[20:23], 0 offen offset:2048 nt lds
    s_waitcnt vmcnt(22)
    buffer_load_dwordx4 v5, s[20:23], 0 offen offset:3072 nt lds
    s_min_u32 s59, s31, 0x803
    s_min_i32 s60, s53, 16
    s_lshl_b32 s95, s59, 17
    s_max_i32 s60, s60, 0
    s_sub_i32 s53, s53, 16
    s_lshl_b32 s99, s60, 13
    s_add_u32 m0, s55, 102400
    s_add_u32 s20, s36, s95
    s_addc_u32 s21, s37, 0
    s_mov_b32 s22, s99
    s_waitcnt vmcnt(21)
    buffer_load_dwordx4 v2, s[20:23], 0 offen nt lds
    s_waitcnt vmcnt(22)
    buffer_load_dwordx4 v3, s[20:23], 0 offen offset:1024 nt lds
    s_waitcnt vmcnt(21)
    buffer_load_dwordx4 v4, s[20:23], 0 offen offset:2048 nt lds
    s_waitcnt vmcnt(22)
    buffer_load_dwordx4 v5, s[20:23], 0 offen offset:3072 nt lds
    s_add_u32 s59, s52, 0
    s_min_u32 s59, s59, 8184
    s_load_dwordx2 s[24:25], s[10:11], s59
    s_add_u32 m0, s55, 8192
    s_add_u32 s20, s38, s88
    s_addc_u32 s21, s39, 0
    s_mov_b32 s22, s64
    s_waitcnt vmcnt(21)
    buffer_load_dwordx4 v6, s[20:23], 0 offen nt lds
    s_waitcnt vmcnt(22)
    buffer_load_dwordx4 v7, s[20:23], 0 offen offset:1024 nt lds
    s_waitcnt vmcnt(21)
    buffer_load_dwordx4 v8, s[20:23], 0 offen offset:2048 nt lds
    s_waitcnt vmcnt(22)
    buffer_load_dwordx4 v9, s[20:23], 0 offen offset:3072 nt lds
    s_add_u32 s59, s52, 8
    s_min_u32 s59, s59, 8184
    s_load_dwordx2 s[26:27], s[10:11], s59
    s_add_u32 m0, s55, 12288
    s_add_u32 s20, s38, s89
    s_addc_u32 s21, s39, 0
    s_mov_b32 s22, s65
    s_waitcnt vmcnt(21)
    buffer_load_dwordx4 v6, s[20:23], 0 offen nt lds
    s_waitcnt vmcnt(22)
    buffer_load_dwordx4 v7, s[20:23], 0 offen offset:1024 nt lds
    s_waitcnt vmcnt(21)
    buffer_load_dwordx4 v8, s[20:23], 0 offen offset:2048 nt lds
    s_waitcnt vmcnt(22)
    buffer_load_dwordx4 v9, s[20:23], 0 offen offset:3072 nt lds
    s_add_u32 s59, s52, 16
    s_min_u32 s59, s59, 8184
    s_load_dwordx2 s[28:29], s[10:11], s59
    s_add_u32 m0, s55, 40960
    s_add_u32 s20, s38, s90
    s_addc_u32 s21, s39, 0
    s_mov_b32 s22, s66
    s_waitcnt vmcnt(21)
    buffer_load_dwordx4 v6, s[20:23], 0 offen nt lds
    s_waitcnt vmcnt(22)
    buffer_load_dwordx4 v7, s[20:23], 0 offen offset:1024 nt lds
    s_waitcnt vmcnt(21)
    buffer_load_dwordx4 v8, s[20:23], 0 offen offset:2048 nt lds
    s_waitcnt vmcnt(22)
    buffer_load_dwordx4 v9, s[20:23], 0 offen offset:3072 nt lds
    s_add_u32 s59, s52, 24
    s_min_u32 s59, s59, 8184
    s_load_dwordx2 s[30:31], s[10:11], s59
    s_add_u32 m0, s55, 45056
    s_add_u32 s20, s38, s91
    s_addc_u32 s21, s39, 0
    s_mov_b32 s22, s67
    s_waitcnt vmcnt(21)
    buffer_load_dwordx4 v6, s[20:23], 0 offen nt lds
    s_waitcnt vmcnt(22)
    buffer_load_dwordx4 v7, s[20:23], 0 offen offset:1024 nt lds
    s_waitcnt vmcnt(21)
    buffer_load_dwordx4 v8, s[20:23], 0 offen offset:2048 nt lds
    s_waitcnt vmcnt(22)
    buffer_load_dwordx4 v9, s[20:23], 0 offen offset:3072 nt lds
    s_add_u32 m0, s55, 73728
    s_add_u32 s20, s38, s92
    s_addc_u32 s21, s39, 0
    s_mov_b32 s22, s96
    s_waitcnt vmcnt(21)
    buffer_load_dwordx4 v6, s[20:23], 0 offen nt lds
    s_waitcnt vmcnt(22)
    buffer_load_dwordx4 v7, s[20:23], 0 offen offset:1024 nt lds
    s_waitcnt vmcnt(21)
    buffer_load_dwordx4 v8, s[20:23], 0 offen offset:2048 nt lds
    s_waitcnt vmcnt(22)
    buffer_load_dwordx4 v9, s[20:23], 0 offen offset:3072 nt lds
    s_add_u32 m0, s55, 77824
    s_add_u32 s20, s38, s93
    s_addc_u32 s21, s39, 0
    s_mov_b32 s22, s97
    s_waitcnt vmcnt(21)
    buffer_load_dwordx4 v6, s[20:23], 0 offen nt lds
    s_waitcnt vmcnt(22)
    buffer_load_dwordx4 v7, s[20:23], 0 offen offset:1024 nt lds
    s_waitcnt vmcnt(21)
    s_barrier
    buffer_load_dwordx4 v8, s[20:23], 0 offen offset:2048 nt lds
    s_waitcnt vmcnt(22)
    buffer_load_dwordx4 v9, s[20:23], 0 offen offset:3072 nt lds
    s_add_u32 m0, s55, 106496
    s_add_u32 s20, s38, s94
    s_addc_u32 s21, s39, 0
    s_mov_b32 s22, s98
    s_waitcnt vmcnt(21)
    buffer_load_dwordx4 v6, s[20:23], 0 offen nt lds
    s_waitcnt vmcnt(22)
    buffer_load_dwordx4 v7, s[20:23], 0 offen offset:1024 nt lds
    s_waitcnt vmcnt(21)
    buffer_load_dwordx4 v8, s[20:23], 0 offen offset:2048 nt lds
    s_waitcnt vmcnt(22)
    buffer_load_dwordx4 v9, s[20:23], 0 offen offset:3072 nt lds
    s_add_u32 m0, s55, 110592
    s_add_u32 s20, s38, s95
    s_addc_u32 s21, s39, 0
    s_mov_b32 s22, s99
    s_waitcnt vmcnt(21)
    buffer_load_dwordx4 v6, s[20:23], 0 offen nt lds
    s_waitcnt vmcnt(22)
    buffer_load_dwordx4 v7, s[20:23], 0 offen offset:1024 nt lds
    s_waitcnt vmcnt(21)
    buffer_load_dwordx4 v8, s[20:23], 0 offen offset:2048 nt lds
    s_waitcnt vmcnt(22)
    buffer_load_dwordx4 v9, s[20:23], 0 offen offset:3072 nt lds
    s_branch L_ld_next
L_ld_small:
    s_cmp_eq_u32 s57, 4
    s_cbranch_scc1 L_ld_mid4
    s_cmp_eq_u32 s57, 2
    s_cbranch_scc1 L_ld_mid2
L_ld_mid6:
    global_store_byte v16, v18, s[16:17]
    global_load_ubyte v19, v17, s[16:17] sc1
    s_min_u32 s59, s24, 0x803
    s_min_i32 s60, s53, 16
    s_lshl_b32 s88, s59, 17
    s_max_i32 s60, s60, 0
    s_sub_i32 s53, s53, 16
    s_lshl_b32 s64, s60, 13
    s_add_u32 m0, s55, 0
    s_add_u32 s20, s36, s88
    s_addc_u32 s21, s37, 0
    s_mov_b32 s22, s64
    s_waitcnt vmcnt(20)
    buffer_load_dwordx4 v2, s[20:23], 0 offen nt lds
    s_waitcnt vmcnt(20)
    buffer_load_dwordx4 v3, s[20:23], 0 offen offset:1024 nt lds
    s_waitcnt vmcnt(20)
    buffer_load_dwordx4 v4, s[20:23], 0 offen offset:2048 nt lds
    s_waitcnt vmcnt(20)
    buffer_load_dwordx4 v5, s[20:23], 0 offen offset:3072 nt lds
    s_min_u32 s59, s25, 0x803
    s_min_i32 s60, s53, 16
    s_lshl_b32 s89, s59, 17
    s_max_i32 s60, s60, 0
    s_sub_i32 s53, s53, 16
    s_lshl_b32 s65, s60, 13
    s_add_u32 m0, s55, 4096
    s_add_u32 s20, s36, s89
    s_addc_u32 s21, s37, 0
    s_mov_b32 s22, s65
    s_waitcnt vmcnt(20)
    buffer_load_dwordx4 v2, s[20:23], 0 offen nt lds
    s_waitcnt vmcnt(20)
    buffer_load_dwordx4 v3, s[20:23], 0 offen offset:1024 nt lds
    s_waitcnt vmcnt(20)
    buffer_load_dwordx4 v4, s[20:23], 0 offen offset:2048 nt lds
    s_waitcnt vmcnt(20)
    buffer_load_dwordx4 v5, s[20:23], 0 offen offset:3072 nt lds
    s_min_u32 s59, s26, 0x803
    s_min_i32 s60, s53, 16
    s_lshl_b32 s90, s59, 17
    s_max_i32 s60, s60, 0
    s_sub_i32 s53, s53, 16
    s_lshl_b32 s66, s60, 13
    s_add_u32 m0, s55, 32768
    s_add_u32 s20, s36, s90
    s_addc_u32 s21, s37, 0
    s_mov_b32 s22, s66
    s_waitcnt vmcnt(20)
    buffer_load_dwordx4 v2, s[20:23], 0 offen nt lds
    s_waitcnt vmcnt(20)
    buffer_load_dwordx4 v3, s[20:23], 0 offen offset:1024 nt lds
    s_waitcnt vmcnt(20)
    buffer_load_dwordx4 v4, s[20:23], 0 offen offset:2048 nt lds
    s_waitcnt vmcnt(20)
    buffer_load_dwordx4 v5, s[20:23], 0 offen offset:3072 nt lds
    s_min_u32 s59, s27, 0x803
    s_min_i32 s60, s53, 16
    s_lshl_b32 s91, s59, 17
    s_max_i32 s60, s60, 0
    s_sub_i32 s53, s53, 16
    s_lshl_b32 s67, s60, 13
    s_add_u32 m0, s55, 36864
    s_add_u32 s20, s36, s91
    s_addc_u32 s21, s37, 0
    s_mov_b32 s22, s67
    s_waitcnt vmcnt(20)
    buffer_load_dwordx4 v2, s[20:23], 0 offen nt lds
    s_waitcnt vmcnt(20)
    buffer_load_dwordx4 v3, s[20:23], 0 offen offset:1024 nt lds
    s_waitcnt vmcnt(20)
    buffer_load_dwordx4 v4, s[20:23], 0 offen offset:2048 nt lds
    s_waitcnt vmcnt(20)
    buffer_load_dwordx4 v5, s[20:23], 0 offen offset:3072 nt lds
    s_min_u32 s59, s28, 0x803
    s_min_i32 s60, s53, 16
    s_lshl_b32 s92, s59, 17
    s_max_i32 s60, s60, 0
    s_sub_i32 s53, s53, 16
    s_lshl_b32 s96, s60, 13
    s_add_u32 m0, s55, 65536
    s_add_u32 s20, s36, s92
    s_addc_u32 s21, s37, 0
    s_mov_b32 s22, s96
    s_waitcnt vmcnt(20)
    buffer_load_dwordx4 v2, s[20:23], 0 offen nt lds
    s_waitcnt vmcnt(20)
    buffer_load_dwordx4 v3, s[20:23], 0 offen offset:1024 nt lds
    s_waitcnt vmcnt(20)
    buffer_load_dwordx4 v4, s[20:23], 0 offen offset:2048 nt lds
    s_waitcnt vmcnt(20)
    s_cmp_eq_u32 s69, 0
    s_cbranch_scc1 L_nb4
    s_barrier
L_nb4:
    buffer_load_dwordx4 v5, s[20:23], 0 offen offset:3072 nt lds
    s_min_u32 s59, s29, 0x803
    s_min_i32 s60, s53, 16
    s_lshl_b32 s93, s59, 17
    s_max_i32 s60, s60, 0
    s_sub_i32 s53, s53, 16
    s_lshl_b32 s97, s60, 13
    s_add_u32 m0, s55, 69632
    s_add_u32 s20, s36, s93
    s_addc_u32 s21, s37, 0
    s_mov_b32 s22, s97
    s_waitcnt vmcnt(20)
    buffer_load_dwordx4 v2, s[20:23], 0 offen nt lds
    s_waitcnt vmcnt(20)
    buffer_load_dwordx4 v3, s[20:23], 0 offen offset:1024 nt lds
    s_waitcnt vmcnt(20)
    buffer_load_dwordx4 v4, s[20:23], 0 offen offset:2048 nt lds
    s_waitcnt vmcnt(20)
    buffer_load_dwordx4 v5, s[20:23], 0 offen offset:3072 nt lds
    s_add_u32 s59, s52, 0
    s_min_u32 s59, s59, 8184
    s_load_dwordx2 s[24:25], s[10:11], s59
    s_add_u32 m0, s55, 8192
    s_add_u32 s20, s38, s88
    s_addc_u32 s21, s39, 0
    s_mov_b32 s22, s64
    s_waitcnt vmcnt(20)
    buffer_load_dwordx4 v6, s[20:23], 0 offen nt lds
    s_waitcnt vmcnt(20)
    buffer_load_dwordx4 v7, s[20:23], 0 offen offset:1024 nt lds
    s_waitcnt vmcnt(20)
    buffer_load_dwordx4 v8, s[20:23], 0 offen offset:2048 nt lds
    s_waitcnt vmcnt(20)
    buffer_load_dwordx4 v9, s[20:23], 0 offen offset:3072 nt lds
    s_add_u32 s59, s52, 8
    s_min_u32 s59, s59, 8184
    s_load_dwordx2 s[26:27], s[10:11], s59
    s_add_u32 m0, s55, 12288
    s_add_u32 s20, s38, s89
    s_addc_u32 s21, s39, 0
    s_mov_b32 s22, s65
    s_waitcnt vmcnt(20)
    buffer_load_dwordx4 v6, s[20:23], 0 offen nt lds
    s_waitcnt vmcnt(20)
    buffer_load_dwordx4 v7, s[20:23], 0 offen offset:1024 nt lds
    s_waitcnt vmcnt(20)
    buffer_load_dwordx4 v8, s[20:23], 0 offen offset:2048 nt lds
    s_waitcnt vmcnt(20)
    buffer_load_dwordx4 v9, s[20:23], 0 offen offset:3072 nt lds
    s_add_u32 s59, s52, 16
    s_min_u32 s59, s59, 8184
    s_load_dwordx2 s[28:29], s[10:11], s59
    s_add_u32 m0, s55, 40960
    s_add_u32 s20, s38, s90
    s_addc_u32 s21, s39, 0
    s_mov_b32 s22, s66
    s_waitcnt vmcnt(20)
    buffer_load_dwordx4 v6, s[20:23], 0 offen nt lds
    s_waitcnt vmcnt(20)
    buffer_load_dwordx4 v7, s[20:23], 0 offen offset:1024 nt lds
    s_waitcnt vmcnt(20)
    buffer_load_dwordx4 v8, s[20:23], 0 offen offset:2048 nt lds
    s_waitcnt vmcnt(20)
    buffer_load_dwordx4 v9, s[20:23], 0 offen offset:3072 nt lds
    s_add_u32 s59, s52, 24
    s_min_u32 s59, s59, 8184
    s_load_dwordx2 s[30:31], s[10:11], s59
    s_add_u32 m0, s55, 45056
    s_add_u32 s20, s38, s91
    s_addc_u32 s21, s39, 0
    s_mov_b32 s22, s67
    s_waitcnt vmcnt(20)
    buffer_load_dwordx4 v6, s[20:23], 0 offen nt lds
    s_waitcnt vmcnt(20)
    buffer_load_dwordx4 v7, s[20:23], 0 offen offset:1024 nt lds
    s_waitcnt vmcnt(20)
    buffer_load_dwordx4 v8, s[20:23], 0 offen offset:2048 nt lds
    s_waitcnt vmcnt(20)
    buffer_load_dwordx4 v9, s[20:23], 0 offen offset:3072 nt lds
    s_add_u32 m0, s55, 73728
    s_add_u32 s20, s38, s92
    s_addc_u32 s21, s39, 0
    s_mov_b32 s22, s96
    s_waitcnt vmcnt(20)
    buffer_load_dwordx4 v6, s[20:23], 0 offen nt lds
    s_waitcnt vmcnt(20)
    buffer_load_dwordx4 v7, s[20:23], 0 offen offset:1024 nt lds
    s_waitcnt vmcnt(20)
    buffer_load_dwordx4 v8, s[20:23], 0 offen offset:2048 nt lds
    s_waitcnt vmcnt(20)
    buffer_load_dwordx4 v9, s[20:23], 0 offen offset:3072 nt lds
    s_add_u32 m0, s55, 77824
    s_add_u32 s20, s38, s93
    s_addc_u32 s21, s39, 0
    s_mov_b32 s22, s97
    s_waitcnt vmcnt(20)
    s_barrier
    buffer_load_dwordx4 v6, s[20:23], 0 offen nt lds
    s_waitcnt vmcnt(20)
    buffer_load_dwordx4 v7, s[20:23], 0 offen offset:1024 nt lds
    s_waitcnt vmcnt(20)
    buffer_load_dwordx4 v8, s[20:23], 0 offen offset:2048 nt lds
    s_waitcnt vmcnt(20)
    buffer_load_dwordx4 v9, s[20:23], 0 offen offset:3072 nt lds
    s_branch L_ld_next
L_ld_mid4:
    global_store_byte v16, v18, s[16:17]
    global_load_ubyte v19, v17, s[16:17] sc1
    s_min_u32 s59, s24, 0x803
    s_min_i32 s60, s53, 16
    s_lshl_b32 s88, s59, 17
    s_max_i32 s60, s60, 0
    s_sub_i32 s53, s53, 16
    s_lshl_b32 s64, s60, 13
    s_add_u32 m0, s55, 0
    s_add_u32 s20, s36, s88
    s_addc_u32 s21, s37, 0
    s_mov_b32 s22, s64
    s_waitcnt vmcnt(20)
    buffer_load_dwordx4 v2, s[20:23], 0 offen nt lds
    s_waitcnt vmcnt(20)
    buffer_load_dwordx4 v3, s[20:23], 0 offen offset:1024 nt lds
    s_waitcnt vmcnt(20)
    buffer_load_dwordx4 v4, s[20:23], 0 offen offset:2048 nt lds
    s_waitcnt vmcnt(20)
    buffer_load_dwordx4 v5, s[20:23], 0 offen offset:3072 nt lds
    s_min_u32 s59, s25, 0x803
    s_min_i32 s60, s53, 16
    s_lshl_b32 s89, s59, 17
    s_max_i32 s60, s60, 0
    s_sub_i32 s53, s53, 16
    s_lshl_b32 s65, s60, 13
    s_add_u32 m0, s55, 4096
    s_add_u32 s20, s36, s89
    s_addc_u32 s21, s37, 0
    s_mov_b32 s22, s65
    s_waitcnt vmcnt(20)
    buffer_load_dwordx4 v2, s[20:23], 0 offen nt lds
    s_waitcnt vmcnt(20)
    buffer_load_dwordx4 v3, s[20:23], 0 offen offset:1024 nt lds
    s_waitcnt vmcnt(20)
    buffer_load_dwordx4 v4, s[20:23], 0 offen offset:2048 nt lds
    s_waitcnt vmcnt(20)
    buffer_load_dwordx4 v5, s[20:23], 0 offen offset:3072 nt lds
    s_min_u32 s59, s26, 0x803
    s_min_i32 s60, s53, 16
    s_lshl_b32 s90, s59, 17
    s_max_i32 s60, s60, 0
    s_sub_i32 s53, s53, 16
    s_lshl_b32 s66, s60, 13
    s_add_u32 m0, s55, 32768
    s_add_u32 s20, s36, s90
    s_addc_u32 s21, s37, 0
    s_mov_b32 s22, s66
    s_waitcnt vmcnt(20)
    buffer_load_dwordx4 v2, s[20:23], 0 offen nt lds
    s_waitcnt vmcnt(20)
    buffer_load_dwordx4 v3, s[20:23], 0 offen offset:1024 nt lds
    s_waitcnt vmcnt(20)
    buffer_load_dwordx4 v4, s[20:23], 0 offen offset:2048 nt lds
    s_waitcnt vmcnt(20)
    buffer_load_dwordx4 v5, s[20:23], 0 offen offset:3072 nt lds
    s_min_u32 s59, s27, 0x803
    s_min_i32 s60, s53, 16
    s_lshl_b32 s91, s59, 17
    s_max_i32 s60, s60, 0
    s_sub_i32 s53, s53, 16
    s_lshl_b32 s67, s60, 13
    s_add_u32 m0, s55, 36864
    s_add_u32 s20, s36, s91
    s_addc_u32 s21, s37, 0
    s_mov_b32 s22, s67
    s_waitcnt vmcnt(20)
    buffer_load_dwordx4 v2, s[20:23], 0 offen nt lds
    s_waitcnt vmcnt(20)
    buffer_load_dwordx4 v3, s[20:23], 0 offen offset:1024 nt lds
    s_waitcnt vmcnt(20)
    buffer_load_dwordx4 v4, s[20:23], 0 offen offset:2048 nt lds
    s_waitcnt vmcnt(20)
    buffer_load_dwordx4 v5, s[20:23], 0 offen offset:3072 nt lds
    s_add_u32 s59, s52, 0
    s_min_u32 s59, s59, 8184
    s_load_dwordx2 s[24:25], s[10:11], s59
    s_add_u32 m0, s55, 8192
    s_add_u32 s20, s38, s88
    s_addc_u32 s21, s39, 0
    s_mov_b32 s22, s64
    s_waitcnt vmcnt(20)
    buffer_load_dwordx4 v6, s[20:23], 0 offen nt lds
    s_waitcnt vmcnt(20)
    buffer_load_dwordx4 v7, s[20:23], 0 offen offset:1024 nt lds
    s_waitcnt vmcnt(20)
    buffer_load_dwordx4 v8, s[20:23], 0 offen offset:2048 nt lds
    s_waitcnt vmcnt(20)
    s_cmp_eq_u32 s69, 0
    s_cbranch_scc1 L_nb5
    s_barrier
L_nb5:
    buffer_load_dwordx4 v9, s[20:23], 0 offen offset:3072 nt lds
    s_add_u32 s59, s52, 8
    s_min_u32 s59, s59, 8184
    s_load_dwordx2 s[26:27], s[10:11], s59
    s_add_u32 m0, s55, 12288
    s_add_u32 s20, s38, s89
    s_addc_u32 s21, s39, 0
    s_mov_b32 s22, s65
    s_waitcnt vmcnt(20)
    buffer_load_dwordx4 v6, s[20:23], 0 offen nt lds
    s_waitcnt vmcnt(20)
    buffer_load_dwordx4 v7, s[20:23], 0 offen offset:1024 nt lds
    s_waitcnt vmcnt(20)
    buffer_load_dwordx4 v8, s[20:23], 0 offen offset:2048 nt lds
    s_waitcnt vmcnt(20)
    buffer_load_dwordx4 v9, s[20:23], 0 offen offset:3072 nt lds
    s_add_u32 s59, s52, 16
    s_min_u32 s59, s59, 8184
    s_load_dwordx2 s[28:29], s[10:11], s59
    s_add_u32 m0, s55, 40960
    s_add_u32 s20, s38, s90
    s_addc_u32 s21, s39, 0
    s_mov_b32 s22, s66
    s_waitcnt vmcnt(20)
    buffer_load_dwordx4 v6, s[20:23], 0 offen nt lds
    s_waitcnt vmcnt(20)
    buffer_load_dwordx4 v7, s[20:23], 0 offen offset:1024 nt lds
    s_waitcnt vmcnt(20)
    buffer_load_dwordx4 v8, s[20:23], 0 offen offset:2048 nt lds
    s_waitcnt vmcnt(20)
    buffer_load_dwordx4 v9, s[20:23], 0 offen offset:3072 nt lds
    s_add_u32 s59, s52, 24
    s_min_u32 s59, s59, 8184
    s_load_dwordx2 s[30:31], s[10:11], s59
    s_add_u32 m0, s55, 45056
    s_add_u32 s20, s38, s91
    s_addc_u32 s21, s39, 0
    s_mov_b32 s22, s67
    s_waitcnt vmcnt(20)
    buffer_load_dwordx4 v6, s[20:23], 0 offen nt lds
    s_waitcnt vmcnt(20)
    buffer_load_dwordx4 v7, s[20:23], 0 offen offset:1024 nt lds
    s_waitcnt vmcnt(20)
    buffer_load_dwordx4 v8, s[20:23], 0 offen offset:2048 nt lds
    s_waitcnt vmcnt(20)
    buffer_load_dwordx4 v9, s[20:23], 0 offen offset:3072 nt lds
    s_waitcnt vmcnt(16)
    s_barrier
    s_branch L_ld_next
L_ld_mid2:
    global_store_byte v16, v18, s[16:17]
    global_load_ubyte v19, v17, s[16:17] sc1
    s_min_u32 s59, s24, 0x803
    s_min_i32 s60, s53, 16
    s_lshl_b32 s88, s59, 17
    s_max_i32 s60, s60, 0
    s_sub_i32 s53, s53, 16
    s_lshl_b32 s64, s60, 13
    s_add_u32 m0, s55, 0
    s_add_u32 s20, s36, s88
    s_addc_u32 s21, s37, 0
    s_mov_b32 s22, s64
    s_waitcnt vmcnt(20)
    buffer_load_dwordx4 v2, s[20:23], 0 offen nt lds
    s_waitcnt vmcnt(20)
    buffer_load_dwordx4 v3, s[20:23], 0 offen offset:1024 nt lds
    s_waitcnt vmcnt(20)
    buffer_load_dwordx4 v4, s[20:23], 0 offen offset:2048 nt lds
    s_waitcnt vmcnt(20)
    buffer_load_dwordx4 v5, s[20:23], 0 offen offset:3072 nt lds
    s_min_u32 s59, s25, 0x803
    s_min_i32 s60, s53, 16
    s_lshl_b32 s89, s59, 17
    s_max_i32 s60, s60, 0
    s_sub_i32 s53, s53, 16
    s_lshl_b32 s65, s60, 13
    s_add_u32 m0, s55, 4096
    s_add_u32 s20, s36, s89
    s_addc_u32 s21, s37, 0
    s_mov_b32 s22, s65
    s_waitcnt vmcnt(20)
    buffer_load_dwordx4 v2, s[20:23], 0 offen nt lds
    s_waitcnt vmcnt(20)
    buffer_load_dwordx4 v3, s[20:23], 0 offen offset:1024 nt lds
    s_waitcnt vmcnt(20)
    buffer_load_dwordx4 v4, s[20:23], 0 offen offset:2048 nt lds
    s_waitcnt vmcnt(20)
    buffer_load_dwordx4 v5, s[20:23], 0 offen offset:3072 nt lds
    s_add_u32 s59, s52, 0
    s_min_u32 s59, s59, 8184
    s_load_dwordx2 s[24:25], s[10:11], s59
    s_add_u32 m0, s55, 8192
    s_add_u32 s20, s38, s88
    s_addc_u32 s21, s39, 0
    s_mov_b32 s22, s64
    s_waitcnt vmcnt(20)
    buffer_load_dwordx4 v6, s[20:23], 0 offen nt lds
    s_waitcnt vmcnt(20)
    buffer_load_dwordx4 v7, s[20:23], 0 offen offset:1024 nt lds
    s_waitcnt vmcnt(20)
    buffer_load_dwordx4 v8, s[20:23], 0 offen offset:2048 nt lds
    s_waitcnt vmcnt(20)
    buffer_load_dwordx4 v9, s[20:23], 0 offen offset:3072 nt lds
    s_add_u32 s59, s52, 8
    s_min_u32 s59, s59, 8184
    s_load_dwordx2 s[26:27], s[10:11], s59
    s_add_u32 m0, s55, 12288
    s_add_u32 s20, s38, s89
    s_addc_u32 s21, s39, 0
    s_mov_b32 s22, s65
    s_waitcnt vmcnt(20)
    buffer_load_dwordx4 v6, s[20:23], 0 offen nt lds
    s_waitcnt vmcnt(20)
    buffer_load_dwordx4 v7, s[20:23], 0 offen offset:1024 nt lds
    s_waitcnt vmcnt(20)
    buffer_load_dwordx4 v8, s[20:23], 0 offen offset:2048 nt lds
    s_waitcnt vmcnt(20)
    buffer_load_dwordx4 v9, s[20:23], 0 offen offset:3072 nt lds
    s_add_u32 s59, s52, 16
    s_min_u32 s59, s59, 8184
    s_load_dwordx2 s[28:29], s[10:11], s59
    s_add_u32 s59, s52, 24
    s_min_u32 s59, s59, 8184
    s_load_dwordx2 s[30:31], s[10:11], s59
    s_waitcnt vmcnt(17)
    s_cmp_eq_u32 s69, 0
    s_cbranch_scc1 L_nb6
    s_barrier
L_nb6:
    s_waitcnt vmcnt(8)
    s_barrier
    s_branch L_ld_next
L_ld_last:
    s_cmp_eq_u32 s57, 6
    s_cbranch_scc1 L_ld_last6
    s_cmp_eq_u32 s57, 4
    s_cbranch_scc1 L_ld_last4
    s_cmp_eq_u32 s57, 2
    s_cbranch_scc1 L_ld_last2
L_ld_last8:
    s_min_u32 s59, s24, 0x803
    s_min_i32 s60, s53, 16
    s_lshl_b32 s88, s59, 17
    s_max_i32 s60, s60, 0
    s_sub_i32 s53, s53, 16
    s_lshl_b32 s64, s60, 13
    s_add_u32 m0, s55, 0
    s_add_u32 s20, s36, s88
    s_addc_u32 s21, s37, 0
    s_mov_b32 s22, s64
    s_waitcnt vmcnt(23)
    buffer_load_dwordx4 v2, s[20:23], 0 offen nt lds
    s_waitcnt vmcnt(23)
    buffer_load_dwordx4 v3, s[20:23], 0 offen offset:1024 nt lds
    s_waitcnt vmcnt(23)
    buffer_load_dwordx4 v4, s[20:23], 0 offen offset:2048 nt lds
    s_waitcnt vmcnt(23)
    buffer_load_dwordx4 v5, s[20:23], 0 offen offset:3072 nt lds
    s_min_u32 s59, s25, 0x803
    s_min_i32 s60, s53, 16
    s_lshl_b32 s89, s59, 17
    s_max_i32 s60, s60, 0
    s_sub_i32 s53, s53, 16
    s_lshl_b32 s65, s60, 13
    s_add_u32 m0, s55, 4096
    s_add_u32 s20, s36, s89
    s_addc_u32 s21, s37, 0
    s_mov_b32 s22, s65
    s_waitcnt vmcnt(23)
    buffer_load_dwordx4 v2, s[20:23], 0 offen nt lds
    s_waitcnt vmcnt(23)
    buffer_load_dwordx4 v3, s[20:23], 0 offen offset:1024 nt lds
    s_waitcnt vmcnt(23)
    buffer_load_dwordx4 v4, s[20:23], 0 offen offset:2048 nt lds
    s_waitcnt vmcnt(23)
    buffer_load_dwordx4 v5, s[20:23], 0 offen offset:3072 nt lds
    s_min_u32 s59, s26, 0x803
    s_min_i32 s60, s53, 16
    s_lshl_b32 s90, s59, 17
    s_max_i32 s60, s60, 0
    s_sub_i32 s53, s53, 16
    s_lshl_b32 s66, s60, 13
    s_add_u32 m0, s55, 32768
    s_add_u32 s20, s36, s90
    s_addc_u32 s21, s37, 0
    s_mov_b32 s22, s66
    s_waitcnt vmcnt(23)
    buffer_load_dwordx4 v2, s[20:23], 0 offen nt lds
    s_waitcnt vmcnt(23)
    buffer_load_dwordx4 v3, s[20:23], 0 offen offset:1024 nt lds
    s_waitcnt vmcnt(23)
    buffer_load_dwordx4 v4, s[20:23], 0 offen offset:2048 nt lds
    s_waitcnt vmcnt(23)
    buffer_load_dwordx4 v5, s[20:23], 0 offen offset:3072 nt lds
    s_min_u32 s59, s27, 0x803
    s_min_i32 s60, s53, 16
    s_lshl_b32 s91, s59, 17
    s_max_i32 s60, s60, 0
    s_sub_i32 s53, s53, 16
    s_lshl_b32 s67, s60, 13
    s_add_u32 m0, s55, 36864
    s_add_u32 s20, s36, s91
    s_addc_u32 s21, s37, 0
    s_mov_b32 s22, s67
    s_waitcnt vmcnt(23)
    buffer_load_dwordx4 v2, s[20:23], 0 offen nt lds
    s_waitcnt vmcnt(23)
    buffer_load_dwordx4 v3, s[20:23], 0 offen offset:1024 nt lds
    s_waitcnt vmcnt(23)
    buffer_load_dwordx4 v4, s[20:23], 0 offen offset:2048 nt lds
    s_waitcnt vmcnt(23)
    buffer_load_dwordx4 v5, s[20:23], 0 offen offset:3072 nt lds
    s_min_u32 s59, s28, 0x803
    s_min_i32 s60, s53, 16
    s_lshl_b32 s92, s59, 17
    s_max_i32 s60, s60, 0
    s_sub_i32 s53, s53, 16
    s_lshl_b32 s96, s60, 13
    s_add_u32 m0, s55, 65536
    s_add_u32 s20, s36, s92
    s_addc_u32 s21, s37, 0
    s_mov_b32 s22, s96
    s_waitcnt vmcnt(23)
    buffer_load_dwordx4 v2, s[20:23], 0 offen nt lds
    s_waitcnt vmcnt(23)
    buffer_load_dwordx4 v3, s[20:23], 0 offen offset:1024 nt lds
    s_waitcnt vmcnt(23)
    buffer_load_dwordx4 v4, s[20:23], 0 offen offset:2048 nt lds
    s_waitcnt vmcnt(23)
    buffer_load_dwordx4 v5, s[20:23], 0 offen offset:3072 nt lds
    s_min_u32 s59, s29, 0x803
    s_min_i32 s60, s53, 16
    s_lshl_b32 s93, s59, 17
    s_max_i32 s60, s60, 0
    s_sub_i32 s53, s53, 16
    s_lshl_b32 s97, s60, 13
    s_add_u32 m0, s55, 69632
    s_add_u32 s20, s36, s93
    s_addc_u32 s21, s37, 0
    s_mov_b32 s22, s97
    s_waitcnt vmcnt(23)
    buffer_load_dwordx4 v2, s[20:23], 0 offen nt lds
    s_waitcnt vmcnt(23)
    buffer_load_dwordx4 v3, s[20:23], 0 offen offset:1024 nt lds
    s_waitcnt vmcnt(23)
    buffer_load_dwordx4 v4, s[20:23], 0 offen offset:2048 nt lds
    s_waitcnt vmcnt(23)
    s_cmp_eq_u32 s69, 0
    s_cbranch_scc1 L_nb7
    s_barrier
L_nb7:
    buffer_load_dwordx4 v5, s[20:23], 0 offen offset:3072 nt lds
    s_min_u32 s59, s30, 0x803
    s_min_i32 s60, s53, 16
    s_lshl_b32 s94, s59, 17
    s_max_i32 s60, s60, 0
    s_sub_i32 s53, s53, 16
    s_lshl_b32 s98, s60, 13
    s_add_u32 m0, s55, 98304
    s_add_u32 s20, s36, s94
    s_addc_u32 s21, s37, 0
    s_mov_b32 s22, s98
    s_waitcnt vmcnt(23)
    buffer_load_dwordx4 v2, s[20:23], 0 offen nt lds
    s_waitcnt vmcnt(23)
    buffer_load_dwordx4 v3, s[20:23], 0 offen offset:1024 nt lds
    s_waitcnt vmcnt(23)
    buffer_load_dwordx4 v4, s[20:23], 0 offen offset:2048 nt lds
    s_waitcnt vmcnt(23)
    buffer_load_dwordx4 v5, s[20:23], 0 offen offset:3072 nt lds
    s_min_u32 s59, s31, 0x803
    s_min_i32 s60, s53, 16
    s_lshl_b32 s95, s59, 17
    s_max_i32 s60, s60, 0
    s_sub_i32 s53, s53, 16
    s_lshl_b32 s99, s60, 13
    s_add_u32 m0, s55, 102400
    s_add_u32 s20, s36, s95
    s_addc_u32 s21, s37, 0
    s_mov_b32 s22, s99
    s_waitcnt vmcnt(23)
    buffer_load_dwordx4 v2, s[20:23], 0 offen nt lds
    s_waitcnt vmcnt(23)
    buffer_load_dwordx4 v3, s[20:23], 0 offen offset:1024 nt lds
    s_waitcnt vmcnt(23)
    buffer_load_dwordx4 v4, s[20:23], 0 offen offset:2048 nt lds
    s_waitcnt vmcnt(23)
    buffer_load_dwordx4 v5, s[20:23], 0 offen offset:3072 nt lds
    s_add_u32 m0, s55, 8192
    s_add_u32 s20, s38, s88
    s_addc_u32 s21, s39, 0
    s_mov_b32 s22, s64
    s_waitcnt vmcnt(23)
    buffer_load_dwordx4 v6, s[20:23], 0 offen nt lds
    s_waitcnt vmcnt(23)
    buffer_load_dwordx4 v7, s[20:23], 0 offen offset:1024 nt lds
    s_waitcnt vmcnt(23)
    buffer_load_dwordx4 v8, s[20:23], 0 offen offset:2048 nt lds
    s_waitcnt vmcnt(23)
    buffer_load_dwordx4 v9, s[20:23], 0 offen offset:3072 nt lds
    s_add_u32 m0, s55, 12288
    s_add_u32 s20, s38, s89
    s_addc_u32 s21, s39, 0
    s_mov_b32 s22, s65
    s_waitcnt vmcnt(23)
    buffer_load_dwordx4 v6, s[20:23], 0 offen nt lds
    s_waitcnt vmcnt(23)
    buffer_load_dwordx4 v7, s[20:23], 0 offen offset:1024 nt lds
    s_waitcnt vmcnt(23)
    buffer_load_dwordx4 v8, s[20:23], 0 offen offset:2048 nt lds
    s_waitcnt vmcnt(23)
    buffer_load_dwordx4 v9, s[20:23], 0 offen offset:3072 nt lds
    s_add_u32 m0, s55, 40960
    s_add_u32 s20, s38, s90
    s_addc_u32 s21, s39, 0
    s_mov_b32 s22, s66
    s_waitcnt vmcnt(23)
    buffer_load_dwordx4 v6, s[20:23], 0 offen nt lds
    s_waitcnt vmcnt(23)
    buffer_load_dwordx4 v7, s[20:23], 0 offen offset:1024 nt lds
    s_waitcnt vmcnt(23)
    buffer_load_dwordx4 v8, s[20:23], 0 offen offset:2048 nt lds
    s_waitcnt vmcnt(23)
    buffer_load_dwordx4 v9, s[20:23], 0 offen offset:3072 nt lds
    s_add_u32 m0, s55, 45056
    s_add_u32 s20, s38, s91
    s_addc_u32 s21, s39, 0
    s_mov_b32 s22, s67
    s_waitcnt vmcnt(23)
    buffer_load_dwordx4 v6, s[20:23], 0 offen nt lds
    s_waitcnt vmcnt(23)
    buffer_load_dwordx4 v7, s[20:23], 0 offen offset:1024 nt lds
    s_waitcnt vmcnt(23)
    buffer_load_dwordx4 v8, s[20:23], 0 offen offset:2048 nt lds
    s_waitcnt vmcnt(23)
    buffer_load_dwordx4 v9, s[20:23], 0 offen offset:3072 nt lds
    s_add_u32 m0, s55, 73728
    s_add_u32 s20, s38, s92
    s_addc_u32 s21, s39, 0
    s_mov_b32 s22, s96
    s_waitcnt vmcnt(23)
    buffer_load_dwordx4 v6, s[20:23], 0 offen nt lds
    s_waitcnt vmcnt(23)
    buffer_load_dwordx4 v7, s[20:23], 0 offen offset:1024 nt lds
    s_waitcnt vmcnt(23)
    buffer_load_dwordx4 v8, s[20:23], 0 offen offset:2048 nt lds
    s_waitcnt vmcnt(23)
    buffer_load_dwordx4 v9, s[20:23], 0 offen offset:3072 nt lds
    s_add_u32 m0, s55, 77824
    s_add_u32 s20, s38, s93
    s_addc_u32 s21, s39, 0
    s_mov_b32 s22, s97
    s_waitcnt vmcnt(23)
    buffer_load_dwordx4 v6, s[20:23], 0 offen nt lds
    s_waitcnt vmcnt(23)
    buffer_load_dwordx4 v7, s[20:23], 0 offen offset:1024 nt lds
    s_waitcnt vmcnt(23)
    buffer_load_dwordx4 v8, s[20:23], 0 offen offset:2048 nt lds
    s_waitcnt vmcnt(23)
    s_barrier
    buffer_load_dwordx4 v9, s[20:23], 0 offen offset:3072 nt lds
    s_add_u32 m0, s55, 106496
    s_add_u32 s20, s38, s94
    s_addc_u32 s21, s39, 0
    s_mov_b32 s22, s98
    s_waitcnt vmcnt(23)
    buffer_load_dwordx4 v6, s[20:23], 0 offen nt lds
    s_waitcnt vmcnt(23)
    buffer_load_dwordx4 v7, s[20:23], 0 offen offset:1024 nt lds
    s_waitcnt vmcnt(23)
    buffer_load_dwordx4 v8, s[20:23], 0 offen offset:2048 nt lds
    s_waitcnt vmcnt(23)
    buffer_load_dwordx4 v9, s[20:23], 0 offen offset:3072 nt lds
    s_add_u32 m0, s55, 110592
    s_add_u32 s20, s38, s95
    s_addc_u32 s21, s39, 0
    s_mov_b32 s22, s99
    s_waitcnt vmcnt(23)
    buffer_load_dwordx4 v6, s[20:23], 0 offen nt lds
    s_waitcnt vmcnt(23)
    buffer_load_dwordx4 v7, s[20:23], 0 offen offset:1024 nt lds
    s_waitcnt vmcnt(23)
    buffer_load_dwordx4 v8, s[20:23], 0 offen offset:2048 nt lds
    s_waitcnt vmcnt(23)
    buffer_load_dwordx4 v9, s[20:23], 0 offen offset:3072 nt lds
    s_waitcnt vmcnt(0)
    s_barrier
    s_endpgm
L_ld_last6:
    s_min_u32 s59, s24, 0x803
    s_min_i32 s60, s53, 16
    s_lshl_b32 s88, s59, 17
    s_max_i32 s60, s60, 0
    s_sub_i32 s53, s53, 16
    s_lshl_b32 s64, s60, 13
    s_add_u32 m0, s55, 0
    s_add_u32 s20, s36, s88
    s_addc_u32 s21, s37, 0
    s_mov_b32 s22, s64
    s_waitcnt vmcnt(23)
    buffer_load_dwordx4 v2, s[20:23], 0 offen nt lds
    s_waitcnt vmcnt(23)
    buffer_load_dwordx4 v3, s[20:23], 0 offen offset:1024 nt lds
    s_waitcnt vmcnt(23)
    buffer_load_dwordx4 v4, s[20:23], 0 offen offset:2048 nt lds
    s_waitcnt vmcnt(23)
    buffer_load_dwordx4 v5, s[20:23], 0 offen offset:3072 nt lds
    s_min_u32 s59, s25, 0x803
    s_min_i32 s60, s53, 16
    s_lshl_b32 s89, s59, 17
    s_max_i32 s60, s60, 0
    s_sub_i32 s53, s53, 16
    s_lshl_b32 s65, s60, 13
    s_add_u32 m0, s55, 4096
    s_add_u32 s20, s36, s89
    s_addc_u32 s21, s37, 0
    s_mov_b32 s22, s65
    s_waitcnt vmcnt(23)
    buffer_load_dwordx4 v2, s[20:23], 0 offen nt lds
    s_waitcnt vmcnt(23)
    buffer_load_dwordx4 v3, s[20:23], 0 offen offset:1024 nt lds
    s_waitcnt vmcnt(23)
    buffer_load_dwordx4 v4, s[20:23], 0 offen offset:2048 nt lds
    s_waitcnt vmcnt(23)
    buffer_load_dwordx4 v5, s[20:23], 0 offen offset:3072 nt lds
    s_min_u32 s59, s26, 0x803
    s_min_i32 s60, s53, 16
    s_lshl_b32 s90, s59, 17
    s_max_i32 s60, s60, 0
    s_sub_i32 s53, s53, 16
    s_lshl_b32 s66, s60, 13
    s_add_u32 m0, s55, 32768
    s_add_u32 s20, s36, s90
    s_addc_u32 s21, s37, 0
    s_mov_b32 s22, s66
    s_waitcnt vmcnt(23)
    buffer_load_dwordx4 v2, s[20:23], 0 offen nt lds
    s_waitcnt vmcnt(23)
    buffer_load_dwordx4 v3, s[20:23], 0 offen offset:1024 nt lds
    s_waitcnt vmcnt(23)
    buffer_load_dwordx4 v4, s[20:23], 0 offen offset:2048 nt lds
    s_waitcnt vmcnt(23)
    buffer_load_dwordx4 v5, s[20:23], 0 offen offset:3072 nt lds
    s_min_u32 s59, s27, 0x803
    s_min_i32 s60, s53, 16
    s_lshl_b32 s91, s59, 17
    s_max_i32 s60, s60, 0
    s_sub_i32 s53, s53, 16
    s_lshl_b32 s67, s60, 13
    s_add_u32 m0, s55, 36864
    s_add_u32 s20, s36, s91
    s_addc_u32 s21, s37, 0
    s_mov_b32 s22, s67
    s_waitcnt vmcnt(23)
    buffer_load_dwordx4 v2, s[20:23], 0 offen nt lds
    s_waitcnt vmcnt(23)
    buffer_load_dwordx4 v3, s[20:23], 0 offen offset:1024 nt lds
    s_waitcnt vmcnt(23)
    buffer_load_dwordx4 v4, s[20:23], 0 offen offset:2048 nt lds
    s_waitcnt vmcnt(23)
    buffer_load_dwordx4 v5, s[20:23], 0 offen offset:3072 nt lds
    s_min_u32 s59, s28, 0x803
    s_min_i32 s60, s53, 16
    s_lshl_b32 s92, s59, 17
    s_max_i32 s60, s60, 0
    s_sub_i32 s53, s53, 16
    s_lshl_b32 s96, s60, 13
    s_add_u32 m0, s55, 65536
    s_add_u32 s20, s36, s92
    s_addc_u32 s21, s37, 0
    s_mov_b32 s22, s96
    s_waitcnt vmcnt(23)
    buffer_load_dwordx4 v2, s[20:23], 0 offen nt lds
    s_waitcnt vmcnt(23)
    buffer_load_dwordx4 v3, s[20:23], 0 offen offset:1024 nt lds
    s_waitcnt vmcnt(23)
    buffer_load_dwordx4 v4, s[20:23], 0 offen offset:2048 nt lds
    s_waitcnt vmcnt(23)
    buffer_load_dwordx4 v5, s[20:23], 0 offen offset:3072 nt lds
    s_min_u32 s59, s29, 0x803
    s_min_i32 s60, s53, 16
    s_lshl_b32 s93, s59, 17
    s_max_i32 s60, s60, 0
    s_sub_i32 s53, s53, 16
    s_lshl_b32 s97, s60, 13
    s_add_u32 m0, s55, 69632
    s_add_u32 s20, s36, s93
    s_addc_u32 s21, s37, 0
    s_mov_b32 s22, s97
    s_waitcnt vmcnt(23)
    buffer_load_dwordx4 v2, s[20:23], 0 offen nt lds
    s_waitcnt vmcnt(23)
    buffer_load_dwordx4 v3, s[20:23], 0 offen offset:1024 nt lds
    s_waitcnt vmcnt(23)
    buffer_load_dwordx4 v4, s[20:23], 0 offen offset:2048 nt lds
    s_waitcnt vmcnt(23)
    s_cmp_eq_u32 s69, 0
    s_cbranch_scc1 L_nb8
    s_barrier
L_nb8:
    buffer_load_dwordx4 v5, s[20:23], 0 offen offset:3072 nt lds
    s_add_u32 m0, s55, 8192
    s_add_u32 s20, s38, s88
    s_addc_u32 s21, s39, 0
    s_mov_b32 s22, s64
    s_waitcnt vmcnt(23)
    buffer_load_dwordx4 v6, s[20:23], 0 offen nt lds
    s_waitcnt vmcnt(23)
    buffer_load_dwordx4 v7, s[20:23], 0 offen offset:1024 nt lds
    s_waitcnt vmcnt(23)
    buffer_load_dwordx4 v8, s[20:23], 0 offen offset:2048 nt lds
    s_waitcnt vmcnt(23)
    buffer_load_dwordx4 v9, s[20:23], 0 offen offset:3072 nt lds
    s_add_u32 m0, s55, 12288
    s_add_u32 s20, s38, s89
    s_addc_u32 s21, s39, 0
    s_mov_b32 s22, s65
    s_waitcnt vmcnt(23)
    buffer_load_dwordx4 v6, s[20:23], 0 offen nt lds
    s_waitcnt vmcnt(23)
    buffer_load_dwordx4 v7, s[20:23], 0 offen offset:1024 nt lds
    s_waitcnt vmcnt(23)
    buffer_load_dwordx4 v8, s[20:23], 0 offen offset:2048 nt lds
    s_waitcnt vmcnt(23)
    buffer_load_dwordx4 v9, s[20:23], 0 offen offset:3072 nt lds
    s_add_u32 m0, s55, 40960
    s_add_u32 s20, s38, s90
    s_addc_u32 s21, s39, 0
    s_mov_b32 s22, s66
    s_waitcnt vmcnt(23)
    buffer_load_dwordx4 v6, s[20:23], 0 offen nt lds
    s_waitcnt vmcnt(23)
    buffer_load_dwordx4 v7, s[20:23], 0 offen offset:1024 nt lds
    s_waitcnt vmcnt(23)
    buffer_load_dwordx4 v8, s[20:23], 0 offen offset:2048 nt lds
    s_waitcnt vmcnt(23)
    buffer_load_dwordx4 v9, s[20:23], 0 offen offset:3072 nt lds
    s_add_u32 m0, s55, 45056
    s_add_u32 s20, s38, s91
    s_addc_u32 s21, s39, 0
    s_mov_b32 s22, s67
    s_waitcnt vmcnt(23)
    buffer_load_dwordx4 v6, s[20:23], 0 offen nt lds
    s_waitcnt vmcnt(23)
    buffer_load_dwordx4 v7, s[20:23], 0 offen offset:1024 nt lds
    s_waitcnt vmcnt(23)
    buffer_load_dwordx4 v8, s[20:23], 0 offen offset:2048 nt lds
    s_waitcnt vmcnt(23)
    buffer_load_dwordx4 v9, s[20:23], 0 offen offset:3072 nt lds
    s_add_u32 m0, s55, 73728
    s_add_u32 s20, s38, s92
    s_addc_u32 s21, s39, 0
    s_mov_b32 s22, s96
    s_waitcnt vmcnt(23)
    buffer_load_dwordx4 v6, s[20:23], 0 offen nt lds
    s_waitcnt vmcnt(23)
    buffer_load_dwordx4 v7, s[20:23], 0 offen offset:1024 nt lds
    s_waitcnt vmcnt(23)
    buffer_load_dwordx4 v8, s[20:23], 0 offen offset:2048 nt lds
    s_waitcnt vmcnt(23)
    buffer_load_dwordx4 v9, s[20:23], 0 offen offset:3072 nt lds
    s_add_u32 m0, s55, 77824
    s_add_u32 s20, s38, s93
    s_addc_u32 s21, s39, 0
    s_mov_b32 s22, s97
    s_waitcnt vmcnt(23)
    buffer_load_dwordx4 v6, s[20:23], 0 offen nt lds
    s_waitcnt vmcnt(23)
    buffer_load_dwordx4 v7, s[20:23], 0 offen offset:1024 nt lds
    s_waitcnt vmcnt(23)
    buffer_load_dwordx4 v8, s[20:23], 0 offen offset:2048 nt lds
    s_waitcnt vmcnt(23)
    s_barrier
    buffer_load_dwordx4 v9, s[20:23], 0 offen offset:3072 nt lds
    s_waitcnt vmcnt(0)
    s_barrier
    s_endpgm
L_ld_last4:
    s_min_u32 s59, s24, 0x803
    s_min_i32 s60, s53, 16
    s_lshl_b32 s88, s59, 17
    s_max_i32 s60, s60, 0
    s_sub_i32 s53, s53, 16
    s_lshl_b32 s64, s60, 13
    s_add_u32 m0, s55, 0
    s_add_u32 s20, s36, s88
    s_addc_u32 s21, s37, 0
    s_mov_b32 s22, s64
    s_waitcnt vmcnt(23)
    buffer_load_dwordx4 v2, s[20:23], 0 offen nt lds
    s_waitcnt vmcnt(23)
    buffer_load_dwordx4 v3, s[20:23], 0 offen offset:1024 nt lds
    s_waitcnt vmcnt(23)
    buffer_load_dwordx4 v4, s[20:23], 0 offen offset:2048 nt lds
    s_waitcnt vmcnt(23)
    buffer_load_dwordx4 v5, s[20:23], 0 offen offset:3072 nt lds
    s_min_u32 s59, s25, 0x803
    s_min_i32 s60, s53, 16
    s_lshl_b32 s89, s59, 17
    s_max_i32 s60, s60, 0
    s_sub_i32 s53, s53, 16
    s_lshl_b32 s65, s60, 13
    s_add_u32 m0, s55, 4096
    s_add_u32 s20, s36, s89
    s_addc_u32 s21, s37, 0
    s_mov_b32 s22, s65
    s_waitcnt vmcnt(23)
    buffer_load_dwordx4 v2, s[20:23], 0 offen nt lds
    s_waitcnt vmcnt(23)
    buffer_load_dwordx4 v3, s[20:23], 0 offen offset:1024 nt lds
    s_waitcnt vmcnt(23)
    buffer_load_dwordx4 v4, s[20:23], 0 offen offset:2048 nt lds
    s_waitcnt vmcnt(23)
    buffer_load_dwordx4 v5, s[20:23], 0 offen offset:3072 nt lds
    s_min_u32 s59, s26, 0x803
    s_min_i32 s60, s53, 16
    s_lshl_b32 s90, s59, 17
    s_max_i32 s60, s60, 0
    s_sub_i32 s53, s53, 16
    s_lshl_b32 s66, s60, 13
    s_add_u32 m0, s55, 32768
    s_add_u32 s20, s36, s90
    s_addc_u32 s21, s37, 0
    s_mov_b32 s22, s66
    s_waitcnt vmcnt(23)
    buffer_load_dwordx4 v2, s[20:23], 0 offen nt lds
    s_waitcnt vmcnt(23)
    buffer_load_dwordx4 v3, s[20:23], 0 offen offset:1024 nt lds
    s_waitcnt vmcnt(23)
    buffer_load_dwordx4 v4, s[20:23], 0 offen offset:2048 nt lds
    s_waitcnt vmcnt(23)
    buffer_load_dwordx4 v5, s[20:23], 0 offen offset:3072 nt lds
    s_min_u32 s59, s27, 0x803
    s_min_i32 s60, s53, 16
    s_lshl_b32 s91, s59, 17
    s_max_i32 s60, s60, 0
    s_sub_i32 s53, s53, 16
    s_lshl_b32 s67, s60, 13
    s_add_u32 m0, s55, 36864
    s_add_u32 s20, s36, s91
    s_addc_u32 s21, s37, 0
    s_mov_b32 s22, s67
    s_waitcnt vmcnt(23)
    buffer_load_dwordx4 v2, s[20:23], 0 offen nt lds
    s_waitcnt vmcnt(23)
    buffer_load_dwordx4 v3, s[20:23], 0 offen offset:1024 nt lds
    s_waitcnt vmcnt(23)
    buffer_load_dwordx4 v4, s[20:23], 0 offen offset:2048 nt lds
    s_waitcnt vmcnt(23)
    buffer_load_dwordx4 v5, s[20:23], 0 offen offset:3072 nt lds
    s_add_u32 m0, s55, 8192
    s_add_u32 s20, s38, s88
    s_addc_u32 s21, s39, 0
    s_mov_b32 s22, s64
    s_waitcnt vmcnt(23)
    buffer_load_dwordx4 v6, s[20:23], 0 offen nt lds
    s_waitcnt vmcnt(23)
    buffer_load_dwordx4 v7, s[20:23], 0 offen offset:1024 nt lds
    s_waitcnt vmcnt(23)
    buffer_load_dwordx4 v8, s[20:23], 0 offen offset:2048 nt lds
    s_waitcnt vmcnt(23)
    buffer_load_dwordx4 v9, s[20:23], 0 offen offset:3072 nt lds
    s_add_u32 m0, s55, 12288
    s_add_u32 s20, s38, s89
    s_addc_u32 s21, s39, 0
    s_mov_b32 s22, s65
    s_waitcnt vmcnt(23)
    buffer_load_dwordx4 v6, s[20:23], 0 offen nt lds
    s_waitcnt vmcnt(23)
    buffer_load_dwordx4 v7, s[20:23], 0 offen offset:1024 nt lds
    s_waitcnt vmcnt(23)
    buffer_load_dwordx4 v8, s[20:23], 0 offen offset:2048 nt lds
    s_waitcnt vmcnt(23)
    s_cmp_eq_u32 s69, 0
    s_cbranch_scc1 L_nb9
    s_barrier
L_nb9:
    buffer_load_dwordx4 v9, s[20:23], 0 offen offset:3072 nt lds
    s_add_u32 m0, s55, 40960
    s_add_u32 s20, s38, s90
    s_addc_u32 s21, s39, 0
    s_mov_b32 s22, s66
    s_waitcnt vmcnt(23)
    buffer_load_dwordx4 v6, s[20:23], 0 offen nt lds
    s_waitcnt vmcnt(23)
    buffer_load_dwordx4 v7, s[20:23], 0 offen offset:1024 nt lds
    s_waitcnt vmcnt(23)
    buffer_load_dwordx4 v8, s[20:23], 0 offen offset:2048 nt lds
    s_waitcnt vmcnt(23)
    buffer_load_dwordx4 v9, s[20:23], 0 offen offset:3072 nt lds
    s_add_u32 m0, s55, 45056
    s_add_u32 s20, s38, s91
    s_addc_u32 s21, s39, 0
    s_mov_b32 s22, s67
    s_waitcnt vmcnt(23)
    buffer_load_dwordx4 v6, s[20:23], 0 offen nt lds
    s_waitcnt vmcnt(23)
    buffer_load_dwordx4 v7, s[20:23], 0 offen offset:1024 nt lds
    s_waitcnt vmcnt(23)
    buffer_load_dwordx4 v8, s[20:23], 0 offen offset:2048 nt lds
    s_waitcnt vmcnt(23)
    buffer_load_dwordx4 v9, s[20:23], 0 offen offset:3072 nt lds
    s_waitcnt vmcnt(16)
    s_barrier
    s_waitcnt vmcnt(0)
    s_barrier
    s_endpgm
L_ld_last2:
    s_min_u32 s59, s24, 0x803
    s_min_i32 s60, s53, 16
    s_lshl_b32 s88, s59, 17
    s_max_i32 s60, s60, 0
    s_sub_i32 s53, s53, 16
    s_lshl_b32 s64, s60, 13
    s_add_u32 m0, s55, 0
    s_add_u32 s20, s36, s88
    s_addc_u32 s21, s37, 0
    s_mov_b32 s22, s64
    s_waitcnt vmcnt(23)
    buffer_load_dwordx4 v2, s[20:23], 0 offen nt lds
    s_waitcnt vmcnt(23)
    buffer_load_dwordx4 v3, s[20:23], 0 offen offset:1024 nt lds
    s_waitcnt vmcnt(23)
    buffer_load_dwordx4 v4, s[20:23], 0 offen offset:2048 nt lds
    s_waitcnt vmcnt(23)
    buffer_load_dwordx4 v5, s[20:23], 0 offen offset:3072 nt lds
    s_min_u32 s59, s25, 0x803
    s_min_i32 s60, s53, 16
    s_lshl_b32 s89, s59, 17
    s_max_i32 s60, s60, 0
    s_sub_i32 s53, s53, 16
    s_lshl_b32 s65, s60, 13
    s_add_u32 m0, s55, 4096
    s_add_u32 s20, s36, s89
    s_addc_u32 s21, s37, 0
    s_mov_b32 s22, s65
    s_waitcnt vmcnt(23)
    buffer_load_dwordx4 v2, s[20:23], 0 offen nt lds
    s_waitcnt vmcnt(23)
    buffer_load_dwordx4 v3, s[20:23], 0 offen offset:1024 nt lds
    s_waitcnt vmcnt(23)
    buffer_load_dwordx4 v4, s[20:23], 0 offen offset:2048 nt lds
    s_waitcnt vmcnt(23)
    buffer_load_dwordx4 v5, s[20:23], 0 offen offset:3072 nt lds
    s_add_u32 m0, s55, 8192
    s_add_u32 s20, s38, s88
    s_addc_u32 s21, s39, 0
    s_mov_b32 s22, s64
    s_waitcnt vmcnt(23)
    buffer_load_dwordx4 v6, s[20:23], 0 offen nt lds
    s_waitcnt vmcnt(23)
    buffer_load_dwordx4 v7, s[20:23], 0 offen offset:1024 nt lds
    s_waitcnt vmcnt(23)
    buffer_load_dwordx4 v8, s[20:23], 0 offen offset:2048 nt lds
    s_waitcnt vmcnt(23)
    buffer_load_dwordx4 v9, s[20:23], 0 offen offset:3072 nt lds
    s_add_u32 m0, s55, 12288
    s_add_u32 s20, s38, s89
    s_addc_u32 s21, s39, 0
    s_mov_b32 s22, s65
    s_waitcnt vmcnt(23)
    buffer_load_dwordx4 v6, s[20:23], 0 offen nt lds
    s_waitcnt vmcnt(23)
    buffer_load_dwordx4 v7, s[20:23], 0 offen offset:1024 nt lds
    s_waitcnt vmcnt(23)
    buffer_load_dwordx4 v8, s[20:23], 0 offen offset:2048 nt lds
    s_waitcnt vmcnt(23)
    buffer_load_dwordx4 v9, s[20:23], 0 offen offset:3072 nt lds
    s_waitcnt vmcnt(16)
    s_cmp_eq_u32 s69, 0
    s_cbranch_scc1 L_nb10
    s_barrier
L_nb10:
    s_waitcnt vmcnt(8)
    s_barrier
    s_waitcnt vmcnt(0)
    s_barrier
    s_endpgm
L_consumer:
    s_sub_u32 s68, s40, 1
    v_and_b32 v28, 31, v1
    v_lshrrev_b32 v11, 5, v1
    v_bfe_u32 v30, v1, 2, 2
    v_lshrrev_b32 v62, 2, v1
    v_lshlrev_b32 v63, 2, v57
    s_sub_u32 s63, 15, s41
    s_movk_i32 s58, 2047
    s_waitcnt lgkmcnt(0)
    global_load_dword v32, v56, s[12:13]
    global_load_dwordx4 v[36:39], v58, s[12:13]
    v_lshl_or_b32 v29, v57, 2, v30
    v_xor_b32 v29, v29, v11
    v_lshlrev_b32 v29, 4, v29
    v_lshl_add_u32 v2, v28, 8, v29
    s_lshl_b32 s26, s68, 15
    v_lshlrev_b32 v29, 5, v28
    v_add_u32 v7, 155648, v29
    s_lshl_b32 s59, s68, 3
    v_add_u32 v6, s59, v7
    v_lshlrev_b32 v29, 4, v28
    v_add_u32 v9, 156672, v29
    s_lshl_b32 s59, s68, 2
    v_add_u32 v8, s59, v9
    v_bfe_u32 v29, v1, 1, 2
    v_xor_b32 v29, v29, v11
    v_lshlrev_b32 v29, 4, v29
    v_lshl_add_u32 v26, v28, 6, v29
    v_bfe_u32 v29, v1, 3, 2
    v_xor_b32 v29, v29, v1
    v_lshlrev_b32 v27, 4, v29
    s_lshl_b32 s59, s68, 6
    v_lshl_add_u32 v29, v62, 8, v58
    v_add_u32 v10, s59, v29
    v_lshl_add_u32 v28, v11, 2, v30
    v_lshlrev_b32 v28, 8, v28
    v_lshl_or_b32 v28, v30, 6, v28
    v_bfe_u32 v29, v1, 4, 1
    v_lshl_or_b32 v28, v29, 5, v28
    v_lshl_or_b32 v28, v57, 3, v28
    v_xor_b32 v28, s59, v28
    v_add_u32 v3, 8192, v28
    v_lshlrev_b32 v29, 4, v1
    v_add_u32 v4, 147456, v29
    s_lshl_b32 s59, s68, 11
    v_add_u32 v5, s59, v4
    s_mov_b32 s32, s14
    s_mov_b32 s33, s15
    s_mov_b32 s34, 0x400000
    s_mov_b32 s35, 0x20000
    v_mov_b32 v22, 0
    v_mov_b32 v23, 0
    ds_write_b64 v6, v[22:23]
    s_waitcnt vmcnt(0)
    v_add_u32 v33, -1, v32
    v_add_u32 v36, -1, v36
    v_add_u32 v37, -1, v37
    v_add_u32 v38, -1, v38
    v_add_u32 v39, -1, v39
    v_min_u32 v33, s58, v33
    v_min_u32 v36, s58, v36
    v_min_u32 v37, s58, v37
    v_min_u32 v38, s58, v38
    v_min_u32 v39, s58, v39
    v_lshl_or_b32 v33, v33, 4, v62
    v_sub_u32 v34, v33, v63
    v_lshl_or_b32 v36, v36, 4, 0
    v_lshl_or_b32 v37, v37, 4, 1
    v_lshl_or_b32 v38, v38, 4, 2
    v_lshl_or_b32 v39, v39, 4, 3
    v_sub_u32 v36, v34, v36
    v_sub_u32 v37, v34, v37
    v_sub_u32 v38, v34, v38
    v_sub_u32 v39, v34, v39
    v_lshrrev_b32 v36, 31, v36
    v_lshrrev_b32 v37, 31, v37
    v_lshrrev_b32 v38, 31, v38
    v_lshrrev_b32 v39, 31, v39
    v_add_u32 v36, v36, v37
    v_add3_u32 v36, v36, v38, v39
    s_nop 1
    v_add_u32_dpp v37, v36, v36 quad_perm:[1,0,3,2] row_mask:0xf bank_mask:0xf
    s_nop 1
    v_add_u32_dpp v36, v37, v37 quad_perm:[2,3,0,1] row_mask:0xf bank_mask:0xf
    v_cmp_eq_u32 s[64:65], s41, v36
    v_cmp_eq_u32 s[66:67], s63, v36
    s_ff1_i32_b64 s59, s[64:65]
    s_ff1_i32_b64 s60, s[66:67]
    v_readlane_b32 s45, v33, s59
    v_readlane_b32 s46, v33, s60
    s_lshr_b32 s43, s59, 2
    s_lshr_b32 s44, s60, 2
    v_readlane_b32 s61, v32, s59
    v_readlane_b32 s63, v32, s60
    s_lshl_b32 s62, s42, 13
    s_lshl_b32 s86, s43, 18
    s_lshl_b32 s87, s44, 18
    s_add_u32 s86, s86, s62
    s_add_u32 s87, s87, s62
    s_cmp_gt_i32 s61, 0
    s_cselect_b32 s20, 0x3e0293ee, 0
    s_cmp_gt_i32 s63, 0
    s_cselect_b32 s21, 0x3e0293ee, 0
    s_mov_b32 s55, 0
    s_mov_b32 s24, 0
    s_mov_b32 s100, 0
    s_mov_b32 s63, 131072
    s_cmp_lg_u32 s68, 3
    s_cbranch_scc1 L_nobtw
    s_lshl_b32 s59, s43, 9
    s_lshl_b32 s60, s44, 9
    v_mov_b32 v29, s59
    v_mov_b32 v30, s60
    v_cmp_eq_u32 vcc, 0, v11
    v_and_b32 v28, 3, v1
    v_lshlrev_b32 v28, 7, v28
    v_cndmask_b32 v29, v30, v29, vcc
    v_add_u32 v29, v29, v28
    global_load_dword v0, v29, s[10:11]
L_nobtw:
L_item:
    s_lshr_b32 s48, s45, 11
    s_lshr_b32 s47, s45, 9
    s_lshr_b32 s51, s45, 4
    s_add_u32 s48, s48, 1
    s_add_u32 s47, s47, 1
    s_add_u32 s51, s51, 1
    s_lshl_b32 s50, s48, 1
    s_cmp_ge_u32 s47, s50
    s_addc_u32 s49, 1, 0
    s_add_u32 s50, s50, s48
    s_cmp_ge_u32 s47, s50
    s_addc_u32 s49, s49, 0
    s_add_u32 s50, s50, s48
    s_cmp_ge_u32 s47, s50
    s_addc_u32 s49, s49, 0
    s_mul_i32 s50, s49, s48
    s_sub_u32 s50, s47, s50
    s_lshl_b32 s60, s47, 5
    s_sub_u32 s22, s51, s60
    s_add_u32 s22, s22, 32
    v_mov_b32 v160, 0
    v_mov_b32 v161, 0
    v_mov_b32 v162, 0
    v_mov_b32 v163, 0
    v_mov_b32 v164, 0
    v_mov_b32 v165, 0
    v_mov_b32 v166, 0
    v_mov_b32 v167, 0
    v_mov_b32 v168, 0
    v_mov_b32 v169, 0
    v_mov_b32 v170, 0
    v_mov_b32 v171, 0
    v_mov_b32 v172, 0
    v_mov_b32 v173, 0
    v_mov_b32 v174, 0
    v_mov_b32 v175, 0
    v_mov_b32 v20, 0xf149f2ca
    v_mov_b32 v21, 0
    s_mov_b32 s56, 0
    s_sub_u32 s27, s48, 1
    s_sub_i32 s29, s27, 0
    s_max_i32 s29, s29, 0
    s_cmp_eq_u32 s100, 0
    s_cselect_b32 s29, -1, s29
    s_waitcnt lgkmcnt(0)
    .p2align 6
L_loop:
    s_cmp_lt_u32 s56, s50
    s_addc_u32 s57, s49, 0
    s_lshl_b32 s23, s57, 1
    s_add_u32 s24, s24, 1
    s_add_u32 s58, s55, s26
    v_add_u32 v12, s58, v2
    v_xor_b32 v13, 32, v12
    v_xor_b32 v14, 64, v12
    v_xor_b32 v15, 96, v12
    v_xor_b32 v16, 128, v12
    v_xor_b32 v17, 160, v12
    v_xor_b32 v18, 192, v12
    v_xor_b32 v19, 224, v12
    v_mov_b32 v23, s24
    v_mov_b32 v22, 0xf149f2ca
    s_barrier
    s_cmp_lg_u32 s63, 0
    s_cbranch_scc1 L_readq
L_noq:
    s_cmp_ge_u32 s68, s57
    s_cbranch_scc1 L_pubmax
    ds_read_b128 v[96:99], v12
    ds_read_b128 v[100:103], v13
    ds_read_b128 v[104:107], v14
    ds_read_b128 v[108:111], v15
    ds_read_b128 v[112:115], v16
    ds_read_b128 v[116:119], v17
    ds_read_b128 v[120:123], v18
    ds_read_b128 v[124:127], v19
    s_waitcnt lgkmcnt(7)
    v_mfma_f32_32x32x16_bf16 v[32:47], v[96:99], v[64:67], 0
    s_waitcnt lgkmcnt(6)
    v_mfma_f32_32x32x16_bf16 v[32:47], v[100:103], v[68:71], v[32:47]
    s_waitcnt lgkmcnt(5)
    v_mfma_f32_32x32x16_bf16 v[32:47], v[104:107], v[72:75], v[32:47]
    s_waitcnt lgkmcnt(4)
    v_mfma_f32_32x32x16_bf16 v[32:47], v[108:111], v[76:79], v[32:47]
    s_waitcnt lgkmcnt(3)
    v_mfma_f32_32x32x16_bf16 v[32:47], v[112:115], v[80:83], v[32:47]
    s_waitcnt lgkmcnt(2)
    v_mfma_f32_32x32x16_bf16 v[32:47], v[116:119], v[84:87], v[32:47]
    s_waitcnt lgkmcnt(1)
    v_mfma_f32_32x32x16_bf16 v[32:47], v[120:123], v[88:91], v[32:47]
    s_waitcnt lgkmcnt(0)
    v_mfma_f32_32x32x16_bf16 v[32:47], v[124:127], v[92:95], v[32:47]
    s_add_u32 s59, s68, 1
    s_cmp_eq_u32 s59, s57
    s_cselect_b32 s59, s27, -1
    s_nop 6
    s_cmp_eq_u32 s56, s59
    s_cbranch_scc1 L_mask
L_nomask:
    v_max3_f32 v28, v32, v33, v34
    v_max3_f32 v29, v35, v36, v37
    v_max3_f32 v30, v38, v39, v40
    v_max3_f32 v31, v41, v42, v43
    v_max3_f32 v28, v28, v44, v45
    v_max3_f32 v29, v29, v46, v47
    v_max3_f32 v28, v28, v30, v31
    v_max_f32 v28, v28, v29
    v_mov_b32 v29, v28
    s_nop 1
    v_permlane32_swap_b32 v28, v29
    v_max_f32 v22, v28, v29
L_pubmax:
    ds_write_b64 v6, v[22:23]
    v_add_u32 v12, s55, v3
    v_add_u32 v13, 0x10000, v12
    s_xor_b32 s55, s55, 16384
L_spin:
    ds_read_b128 v[56:59], v7
    ds_read_b128 v[60:63], v7 offset:16
    s_waitcnt lgkmcnt(0)
    v_min3_u32 v28, v57, v59, v61
    v_min_u32 v28, v28, v63
    v_cmp_ne_u32 vcc, s24, v28
    v_max3_f32 v28, v56, v58, v20
    s_and_b64 vcc, exec, vcc
    s_cbranch_vccnz L_spin
    v_max3_f32 v28, v28, v60, v62
    v_sub_f32 v29, v20, v28
    v_mul_f32 v30, s20, v28
    v_mul_f32 v29, s20, v29
    v_mov_b32 v20, v28
    v_exp_f32 v24, v29
    s_cmp_ge_u32 s68, s57
    s_cbranch_scc1 L_notile
    v_fma_f32 v32, v32, s20, -v30
    v_fma_f32 v33, v33, s20, -v30
    v_fma_f32 v34, v34, s20, -v30
    v_fma_f32 v35, v35, s20, -v30
    v_fma_f32 v36, v36, s20, -v30
    v_fma_f32 v37, v37, s20, -v30
    v_fma_f32 v38, v38, s20, -v30
    v_fma_f32 v39, v39, s20, -v30
    v_fma_f32 v40, v40, s20, -v30
    v_fma_f32 v41, v41, s20, -v30
    v_fma_f32 v42, v42, s20, -v30
    v_fma_f32 v43, v43, s20, -v30
    v_fma_f32 v44, v44, s20, -v30
    v_fma_f32 v45, v45, s20, -v30
    v_fma_f32 v46, v46, s20, -v30
    v_fma_f32 v47, v47, s20, -v30
    v_exp_f32 v32, v32
    v_exp_f32 v33, v33
    v_exp_f32 v34, v34
    v_exp_f32 v35, v35
    v_exp_f32 v36, v36
    v_exp_f32 v37, v37
    v_exp_f32 v38, v38
    v_exp_f32 v39, v39
    v_exp_f32 v40, v40
    v_exp_f32 v41, v41
    v_cvt_pk_bf16_f32 v48, v32, v33
    v_exp_f32 v42, v42
    v_exp_f32 v43, v43
    v_cvt_pk_bf16_f32 v49, v34, v35
    v_exp_f32 v44, v44
    v_exp_f32 v45, v45
    v_cvt_pk_bf16_f32 v50, v36, v37
    v_exp_f32 v46, v46
    v_exp_f32 v47, v47
    v_cvt_pk_bf16_f32 v51, v38, v39
    ds_write_b128 v5, v[48:51]
    v_cvt_pk_bf16_f32 v52, v40, v41
    v_cvt_pk_bf16_f32 v53, v42, v43
    v_cvt_pk_bf16_f32 v54, v44, v45
    v_cvt_pk_bf16_f32 v55, v46, v47
    ds_write_b128 v5, v[52:55] offset:1024
    v_pk_add_f32 v[32:33], v[32:33], v[40:41]
    v_pk_add_f32 v[34:35], v[34:35], v[42:43]
    v_pk_add_f32 v[36:37], v[36:37], v[44:45]
    v_pk_add_f32 v[38:39], v[38:39], v[46:47]
    v_pk_add_f32 v[32:33], v[32:33], v[36:37]
    v_pk_add_f32 v[34:35], v[34:35], v[38:39]
    v_pk_add_f32 v[32:33], v[32:33], v[34:35]
    v_fma_f32 v21, v21, v24, v32
    v_add_f32 v21, v21, v33
L_scale:
    v_mov_b32 v28, v21
    v_mov_b32 v29, v21
    v_pk_mul_f32 v[160:161], v[160:161], v[24:25] op_sel_hi:[1,0]
    v_pk_mul_f32 v[162:163], v[162:163], v[24:25] op_sel_hi:[1,0]
    v_pk_mul_f32 v[164:165], v[164:165], v[24:25] op_sel_hi:[1,0]
    v_pk_mul_f32 v[166:167], v[166:167], v[24:25] op_sel_hi:[1,0]
    v_pk_mul_f32 v[168:169], v[168:169], v[24:25] op_sel_hi:[1,0]
    v_pk_mul_f32 v[170:171], v[170:171], v[24:25] op_sel_hi:[1,0]
    v_pk_mul_f32 v[172:173], v[172:173], v[24:25] op_sel_hi:[1,0]
    v_pk_mul_f32 v[174:175], v[174:175], v[24:25] op_sel_hi:[1,0]
    v_permlane32_swap_b32 v28, v29
    v_add_f32 v28, v28, v29
    ds_write_b32 v8, v28
    s_cmp_lg_u32 s56, s29
    s_cbranch_scc1 L_nolate
    s_add_u32 s59, s28, 4096
    buffer_store_dwordx4 v[176:179], v10, s[32:35], s28 offen
    buffer_store_dwordx4 v[180:183], v10, s[32:35], s59 offen
L_nolate:
    s_waitcnt lgkmcnt(0)
    s_barrier
    ds_read_b128 v[56:59], v9
    ds_read_b128 v[128:131], v4 offset:0
    ds_read_b64_tr_b16 v[96:97], v12 offset:0
    ds_read_b64_tr_b16 v[98:99], v12 offset:2048
    ds_read_b128 v[132:135], v4 offset:1024
    ds_read_b64_tr_b16 v[100:101], v12 offset:4096
    ds_read_b64_tr_b16 v[102:103], v12 offset:6144
    ds_read_b128 v[136:139], v4 offset:2048
    ds_read_b64_tr_b16 v[104:105], v12 offset:32768
    ds_read_b64_tr_b16 v[106:107], v12 offset:34816
    ds_read_b128 v[140:143], v4 offset:3072
    ds_read_b64_tr_b16 v[108:109], v12 offset:36864
    ds_read_b64_tr_b16 v[110:111], v12 offset:38912
    s_waitcnt lgkmcnt(9)
    v_mfma_f32_32x32x16_bf16 v[160:175], v[96:99], v[128:131], v[160:175]
    ds_read_b128 v[144:147], v4 offset:4096
    ds_read_b64_tr_b16 v[112:113], v13 offset:0
    ds_read_b64_tr_b16 v[114:115], v13 offset:2048
    s_waitcnt lgkmcnt(9)
    v_mfma_f32_32x32x16_bf16 v[160:175], v[100:103], v[132:135], v[160:175]
    ds_read_b128 v[148:151], v4 offset:5120
    ds_read_b64_tr_b16 v[116:117], v13 offset:4096
    ds_read_b64_tr_b16 v[118:119], v13 offset:6144
    s_cmp_eq_u32 s23, 2
    s_cbranch_scc1 L_pvdone
    s_waitcnt lgkmcnt(9)
    v_mfma_f32_32x32x16_bf16 v[160:175], v[104:107], v[136:139], v[160:175]
    ds_read_b128 v[152:155], v4 offset:6144
    ds_read_b64_tr_b16 v[120:121], v13 offset:32768
    ds_read_b64_tr_b16 v[122:123], v13 offset:34816
    s_waitcnt lgkmcnt(9)
    v_mfma_f32_32x32x16_bf16 v[160:175], v[108:111], v[140:143], v[160:175]
    ds_read_b128 v[156:159], v4 offset:7168
    ds_read_b64_tr_b16 v[124:125], v13 offset:36864
    ds_read_b64_tr_b16 v[126:127], v13 offset:38912
    s_cmp_eq_u32 s23, 4
    s_cbranch_scc1 L_pvdone
    s_waitcnt lgkmcnt(9)
    v_mfma_f32_32x32x16_bf16 v[160:175], v[112:115], v[144:147], v[160:175]
    s_waitcnt lgkmcnt(6)
    v_mfma_f32_32x32x16_bf16 v[160:175], v[116:119], v[148:151], v[160:175]
    s_cmp_eq_u32 s23, 6
    s_cbranch_scc1 L_pvdone
    s_waitcnt lgkmcnt(3)
    v_mfma_f32_32x32x16_bf16 v[160:175], v[120:123], v[152:155], v[160:175]
    s_waitcnt lgkmcnt(0)
    v_mfma_f32_32x32x16_bf16 v[160:175], v[124:127], v[156:159], v[160:175]
L_pvdone:
    s_cmp_eq_u32 s56, s27
    s_cbranch_scc1 L_final
    s_add_u32 s56, s56, 1
    s_waitcnt lgkmcnt(0)
    s_branch L_loop
L_notile:
    v_mul_f32 v21, v21, v24
    s_branch L_scale
L_readq:
    v_add_u32 v56, s63, v2
    v_xor_b32 v57, 32, v56
    v_xor_b32 v58, 64, v56
    v_xor_b32 v59, 96, v56
    v_xor_b32 v60, 128, v56
    v_xor_b32 v61, 160, v56
    v_xor_b32 v62, 192, v56
    v_xor_b32 v63, 224, v56
    ds_read_b128 v[64:67], v56
    ds_read_b128 v[68:71], v57
    ds_read_b128 v[72:75], v58
    ds_read_b128 v[76:79], v59
    ds_read_b128 v[80:83], v60
    ds_read_b128 v[84:87], v61
    ds_read_b128 v[88:91], v62
    ds_read_b128 v[92:95], v63
    s_mov_b32 s63, 0
    s_waitcnt lgkmcnt(0)
    s_branch L_noq
L_mask:
    v_sub_u32 v28, s22, v11
    v_mov_b32 v29, 0xf149f2ca
    v_cmp_lt_i32 vcc, 0, v28
    s_nop 1
    v_cndmask_b32 v32, v29, v32, vcc
    v_cmp_lt_i32 vcc, 4, v28
    s_nop 1
    v_cndmask_b32 v33, v29, v33, vcc
    v_cmp_lt_i32 vcc, 8, v28
    s_nop 1
    v_cndmask_b32 v34, v29, v34, vcc
    v_cmp_lt_i32 vcc, 12, v28
    s_nop 1
    v_cndmask_b32 v35, v29, v35, vcc
    v_cmp_lt_i32 vcc, 2, v28
    s_nop 1
    v_cndmask_b32 v36, v29, v36, vcc
    v_cmp_lt_i32 vcc, 6, v28
    s_nop 1
    v_cndmask_b32 v37, v29, v37, vcc
    v_cmp_lt_i32 vcc, 10, v28
    s_nop 1
    v_cndmask_b32 v38, v29, v38, vcc
    v_cmp_lt_i32 vcc, 14, v28
    s_nop 1
    v_cndmask_b32 v39, v29, v39, vcc
    v_cmp_lt_i32 vcc, 16, v28
    s_nop 1
    v_cndmask_b32 v40, v29, v40, vcc
    v_cmp_lt_i32 vcc, 20, v28
    s_nop 1
    v_cndmask_b32 v41, v29, v41, vcc
    v_cmp_lt_i32 vcc, 24, v28
    s_nop 1
    v_cndmask_b32 v42, v29, v42, vcc
    v_cmp_lt_i32 vcc, 28, v28
    s_nop 1
    v_cndmask_b32 v43, v29, v43, vcc
    v_cmp_lt_i32 vcc, 18, v28
    s_nop 1
    v_cndmask_b32 v44, v29, v44, vcc
    v_cmp_lt_i32 vcc, 22, v28
    s_nop 1
    v_cndmask_b32 v45, v29, v45, vcc
    v_cmp_lt_i32 vcc, 26, v28
    s_nop 1
    v_cndmask_b32 v46, v29, v46, vcc
    v_cmp_lt_i32 vcc, 30, v28
    s_nop 1
    v_cndmask_b32 v47, v29, v47, vcc
    s_branch L_nomask
L_final:
    v_add_f32 v28, v56, v57
    v_add_f32 v29, v58, v59
    v_add_f32 v28, v28, v29
    v_rcp_f32 v24, v28
    s_xor_b32 s59, s55, 16384
    s_add_u32 s59, s59, s26
    v_add_u32 v14, s59, v26
    v_xor_b32 v15, 32, v14
    v_add_u32 v16, s59, v27
    s_add_u32 s59, s86, 4096
    v_pk_mul_f32 v[160:161], v[160:161], v[24:25] op_sel_hi:[1,0]
    v_pk_mul_f32 v[162:163], v[162:163], v[24:25] op_sel_hi:[1,0]
    v_pk_mul_f32 v[164:165], v[164:165], v[24:25] op_sel_hi:[1,0]
    v_pk_mul_f32 v[166:167], v[166:167], v[24:25] op_sel_hi:[1,0]
    v_pk_mul_f32 v[168:169], v[168:169], v[24:25] op_sel_hi:[1,0]
    v_pk_mul_f32 v[170:171], v[170:171], v[24:25] op_sel_hi:[1,0]
    v_pk_mul_f32 v[172:173], v[172:173], v[24:25] op_sel_hi:[1,0]
    v_pk_mul_f32 v[174:175], v[174:175], v[24:25] op_sel_hi:[1,0]
    v_cvt_pk_bf16_f32 v48, v160, v161
    v_cvt_pk_bf16_f32 v49, v162, v163
    v_cvt_pk_bf16_f32 v50, v164, v165
    v_cvt_pk_bf16_f32 v51, v166, v167
    v_cvt_pk_bf16_f32 v52, v168, v169
    v_cvt_pk_bf16_f32 v53, v170, v171
    v_cvt_pk_bf16_f32 v54, v172, v173
    v_cvt_pk_bf16_f32 v55, v174, v175
    v_permlane32_swap_b32 v48, v50
    v_permlane32_swap_b32 v49, v51
    v_permlane32_swap_b32 v52, v54
    v_permlane32_swap_b32 v53, v55
    ds_write_b128 v14, v[48:51]
    ds_write_b128 v15, v[52:55]
    s_cmp_lg_u32 s100, 0
    s_cbranch_scc1 L_fin2
    ds_read_b128 v[176:179], v16
    ds_read_b128 v[180:183], v16 offset:1024
    s_mov_b32 s28, s86
    s_branch L_fin1
L_fin2:
    ds_read_b128 v[32:35], v16
    ds_read_b128 v[36:39], v16 offset:1024
    s_waitcnt lgkmcnt(1)
    buffer_store_dwordx4 v[32:35], v10, s[32:35], s86 offen
    s_waitcnt lgkmcnt(0)
    buffer_store_dwordx4 v[36:39], v10, s[32:35], s59 offen
    s_cmp_lg_u32 s100, 0
    s_cbranch_scc1 L_end
L_fin1:
    s_mov_b32 s100, 1
    s_mov_b32 s20, s21
    s_mov_b32 s86, s87
    s_mov_b32 s45, s46
    s_mov_b32 s63, 139264
    s_branch L_item
L_end:
L_done:
    s_endpgm
.section .rodata,"a"
.p2align 6
.amdhsa_kernel standalone__paged_block_table_kv_pagedattention__sampling_kernel
  .amdhsa_next_free_vgpr 184
  .amdhsa_next_free_sgpr 102
  .amdhsa_accum_offset 184
  .amdhsa_group_segment_fixed_size 0
  .amdhsa_kernarg_size 64
  .amdhsa_user_sgpr_count 2
  .amdhsa_user_sgpr_kernarg_segment_ptr 1
  .amdhsa_system_sgpr_workgroup_id_x 1
  .amdhsa_float_denorm_mode_32 3
.end_amdhsa_kernel
```
